```python
import torch

def _softmax(x, axis=-1):
    return torch.softmax(x, dim=axis)

def _gelu(x):
    return torch.nn.functional.gelu(x, approximate='tanh')

def _silu(x):
    return torch.nn.functional.silu(x)

def _sigmoid(x):
    return torch.sigmoid(x)

def _layernorm(x, axis=-1, eps=1e-05):
    m = x.mean(dim=axis, keepdim=True)
    v = x.var(dim=axis, keepdim=True, unbiased=False)
    return (x - m) / torch.sqrt(v + eps)

def _scatter_add(tgt, idx, src, axis=0):
    return tgt.clone().index_add_(axis, idx, src)

def _segment_sum(src, seg, n):
    out = torch.zeros((n,) + src.shape[1:], dtype=src.dtype)
    return out.index_add_(0, seg, src)

def _pad(x, pw):
    flat = tuple((v for pair in reversed(pw) for v in pair))
    return torch.nn.functional.pad(x, flat)
kernel_name = 'adaLN_cond__sliding_block_cached__glu_gated_bilinear__decode'

def setup_inputs():

    _w = lambda a: (lambda t: t.to(torch.bfloat16) if t.is_floating_point() else t)(torch.as_tensor(a))

    def _A_setup():
        B, Sq, D = (2, 1, 512)
        Hq, Hkv, Sk, Dh = (32, 8, 32768, 128)
        assert Hq % Hkv == 0, (Hq, Hkv)
        return {'x': _w((lambda *s: torch.randn(*s, dtype=torch.bfloat16) * 0.05)(B, Sq, D)), 'k_cache': _w((lambda *s: torch.randn(*s, dtype=torch.bfloat16) * 3.2)(B, Hkv, Sk, Dh)), 'v_cache': _w((lambda *s: torch.randn(*s, dtype=torch.bfloat16) * 3.2)(B, Hkv, Sk, Dh)), 'wq': _w((lambda *s: torch.randn(*s, dtype=torch.bfloat16) * 3.2)(D, Hq * Dh) * D ** (-0.5)), 'wo': _w((lambda *s: torch.randn(*s, dtype=torch.bfloat16) * 3.2)(Hq * Dh, D) * (Hq * Dh) ** (-0.5))}
    _A_in = _A_setup()

    def _B_setup():
        B, S, D, F = (2, 1, 512, 1792)
        return {'x': _w((lambda *s: torch.randn(*s, dtype=torch.bfloat16) * 0.05)(B, S, D)), 'w_gate': _w((lambda *s: torch.randn(*s, dtype=torch.bfloat16) * 3.2)(D, F) * D ** (-0.5)), 'w_up': _w((lambda *s: torch.randn(*s, dtype=torch.bfloat16) * 3.2)(D, F) * D ** (-0.5)), 'w_down': _w((lambda *s: torch.randn(*s, dtype=torch.bfloat16) * 3.2)(F, D) * F ** (-0.5))}
    _B_in = _B_setup()
    return {'A_x': _A_in['x'], 'A_k_cache': _A_in['k_cache'], 'A_v_cache': _A_in['v_cache'], 'A_wq': _A_in['wq'], 'A_wo': _A_in['wo'], 'B_x': _B_in['x'], 'B_w_gate': _B_in['w_gate'], 'B_w_up': _B_in['w_up'], 'B_w_down': _B_in['w_down'], 'c': _w((lambda *s: torch.randn(*s, dtype=torch.bfloat16) * 0.2)(2, 512) * 8.0), 'w_mod': _w((lambda *s: torch.randn(*s, dtype=torch.bfloat16) * 0.2)(512, 6 * 512) * 512 ** (-0.5) * 8.0)}

def reference(A_x, A_k_cache, A_v_cache, A_wq, A_wo, B_x, B_w_gate, B_w_up, B_w_down, c, w_mod):

    def _A_ref(x, k_cache, v_cache, wq, wo):
        B, Sq, D = x.shape
        Hq, Dh = (32, 128)
        Hkv, Sk = (k_cache.shape[1], k_cache.shape[2])
        W = min(4096, max(256, Sk // 4))
        rep = Hq // Hkv
        q = (lambda x, *d: x.permute(*d))((x @ wq).reshape(B, Sq, Hq, Dh), 0, 2, 1, 3)
        k = (lambda x, n, axis: torch.repeat_interleave(x, n, dim=axis))(k_cache[:, :, Sk - W:, :], rep, axis=1)
        v = (lambda x, n, axis: torch.repeat_interleave(x, n, dim=axis))(v_cache[:, :, Sk - W:, :], rep, axis=1)
        scores = torch.einsum('bhqd,bhkd->bhqk', q, k) * Dh ** (-0.5)
        p = _softmax(scores, axis=-1)
        o = torch.einsum('bhqk,bhkd->bhqd', p, v)
        return (lambda x, *d: x.permute(*d))(o, 0, 2, 1, 3).reshape(B, Sq, Hq * Dh) @ wo

    def _B_ref(x, w_gate, w_up, w_down):
        g = torch.einsum('bsd,df->bsf', x, w_gate)
        u = torch.einsum('bsd,df->bsf', x, w_up)
        h = g * u
        return torch.einsum('bsf,fd->bsd', h, w_down)
    x = A_x
    mod = (_silu(c) @ w_mod).reshape(c.shape[0], 6, 1, -1)
    sa, ca, ga, sb, cb, gb = (mod[:, 0].clone(), mod[:, 1].clone(), mod[:, 2].clone(), mod[:, 3].clone(), mod[:, 4].clone(), mod[:, 5].clone())
    h = _layernorm(x, axis=-1) * (1 + ca) + sa
    x = x + ga * _A_ref(h, A_k_cache, A_v_cache, A_wq, A_wo)
    h = _layernorm(x, axis=-1) * (1 + cb) + sb
    x = x + gb * _B_ref(h, B_w_gate, B_w_up, B_w_down)
    return x
```

```asm
; @launch grid=(256,1,1) block=(384,1,1) lds=150272
.amdgcn_target "amdgcn-amd-amdhsa--gfx950"
.text
.globl adaLN_cond__sliding_block_cached__glu_gated_bilinear__decode_kernel
.p2align 8
.type adaLN_cond__sliding_block_cached__glu_gated_bilinear__decode_kernel,@function
adaLN_cond__sliding_block_cached__glu_gated_bilinear__decode_kernel:
    s_cmp_ge_u32 s2, 256
    s_cbranch_scc1 L_end
    s_load_dwordx16 s[16:31], s[0:1], 0
    s_load_dwordx8 s[32:39], s[0:1], 64
    s_load_dwordx4 s[40:43], s[0:1], 96
    v_lshrrev_b32 v8, 6, v0
    v_and_b32 v1, 63, v0
    s_and_b32 s4, s2, 7
    v_readfirstlane_b32 s3, v8
    s_lshr_b32 s5, s2, 3
    v_and_b32 v2, 15, v1
    v_lshrrev_b32 v3, 4, v1
    s_and_b32 s6, s5, 1
    s_lshr_b32 s7, s5, 1
    s_cmp_ge_u32 s3, 4
    s_cbranch_scc1 L_svc
    s_cmp_ge_u32 s5, 12
    s_cbranch_scc1 L_bulk
L_head:
    s_setprio 3
    v_lshrrev_b32 v11, 3, v1
    v_and_b32 v9, 7, v1
    v_bfe_u32 v10, v11, 1, 2
    v_lshlrev_b32 v10, 1, v10
    v_xor_b32 v9, v9, v10
    v_lshlrev_b32 v9, 4, v9
    s_cmp_lt_u32 s5, 4
    s_cbranch_scc1 L_ph
    s_barrier
    v_lshl_add_u32 v11, v11, 13, v9
    s_sub_u32 s48, s5, 4
    s_lshl_b32 s49, s4, 10
    s_lshl_b32 s50, s48, 7
    s_add_u32 s49, s49, s50
    s_lshl_b32 s50, s3, 20
    s_add_u32 s50, s50, s49
    s_lshl_b32 s51, s3, 14
    s_mov_b32 s52, 16
    s_waitcnt lgkmcnt(0)
    s_mov_b32 s12, s22
    s_mov_b32 s13, s23
    s_mov_b32 s14, 4194304
    s_mov_b32 s15, 0x20000
L_pq_dma:
    s_mov_b32 m0, s51
    s_add_u32 s51, s51, 1024
    buffer_load_dwordx4 v11, s[12:15], s50 offen nt lds
    s_add_u32 s50, s50, 65536
    s_sub_u32 s52, s52, 1
    s_cmp_lg_u32 s52, 0
    s_cbranch_scc1 L_pq_dma
    s_branch L_pq_rest
L_ph:
    v_mul_u32_u24 v11, 6144, v11
    v_add_u32 v11, v11, v9
    s_lshl_b32 s49, s3, 9
    v_lshlrev_b32 v8, 3, v1
    v_add_u32 v8, s49, v8
    s_mul_i32 s50, s6, 1572864
    s_lshl_b32 s49, s7, 10
    s_add_u32 s50, s50, s49
    s_lshl_b32 s49, s4, 7
    s_add_u32 s50, s50, s49
    s_mul_i32 s49, s3, 393216
    s_add_u32 s50, s50, s49
    s_lshl_b32 s51, s3, 13
    s_waitcnt lgkmcnt(0)
    s_mov_b32 s12, s36
    s_mov_b32 s13, s37
    s_mov_b32 s14, 3145728
    s_mov_b32 s15, 0x20000
    global_load_dwordx2 v[20:21], v8, s[34:35]
    s_mov_b32 m0, s51
    s_add_u32 s51, s51, 1024
    buffer_load_dwordx4 v11, s[12:15], s50 offen nt lds
    s_add_u32 s50, s50, 49152
    s_mov_b32 m0, s51
    s_add_u32 s51, s51, 1024
    buffer_load_dwordx4 v11, s[12:15], s50 offen nt lds
    s_add_u32 s50, s50, 49152
    s_mov_b32 m0, s51
    s_add_u32 s51, s51, 1024
    buffer_load_dwordx4 v11, s[12:15], s50 offen nt lds
    s_add_u32 s50, s50, 49152
    s_mov_b32 m0, s51
    s_add_u32 s51, s51, 1024
    buffer_load_dwordx4 v11, s[12:15], s50 offen nt lds
    s_add_u32 s50, s50, 49152
    s_mov_b32 m0, s51
    s_add_u32 s51, s51, 1024
    buffer_load_dwordx4 v11, s[12:15], s50 offen nt lds
    s_add_u32 s50, s50, 49152
    s_mov_b32 m0, s51
    s_add_u32 s51, s51, 1024
    buffer_load_dwordx4 v11, s[12:15], s50 offen nt lds
    s_add_u32 s50, s50, 49152
    s_mov_b32 m0, s51
    s_add_u32 s51, s51, 1024
    buffer_load_dwordx4 v11, s[12:15], s50 offen nt lds
    s_add_u32 s50, s50, 49152
    s_mov_b32 m0, s51
    s_add_u32 s51, s51, 1024
    buffer_load_dwordx4 v11, s[12:15], s50 offen nt lds
    s_add_u32 s50, s50, 49152
    s_branch L_ph_rest
L_svc:
    s_setprio 3
    s_sub_u32 s62, s3, 4
    v_lshlrev_b32 v8, 2, v1
    v_add_u32 v8, 142656, v8
    v_mov_b32 v9, 0
    s_cmp_eq_u32 s62, 0
    s_cbranch_scc0 L_svc_nz
    s_mov_b32 exec_hi, 0
    ds_write_b32 v8, v9
    s_mov_b64 exec, -1
    s_waitcnt lgkmcnt(0)
L_svc_nz:
    s_sub_u32 s48, s5, 4
    s_cmp_lt_u32 s48, 8
    s_cbranch_scc0 L_svc_noz
    s_barrier
L_svc_noz:
    v_lshlrev_b32 v5, 4, v1
    s_sub_u32 s48, s5, 4
    s_cmp_lt_u32 s48, 8
    s_cselect_b32 s55, 1, 0
    s_cmp_lt_u32 s5, 4
    s_cselect_b32 s54, 1, 0
    s_cmp_ge_u32 s5, 28
    s_cselect_b32 s63, 1, 0
    s_or_b32 s60, s55, s54
    s_mov_b32 s61, s63
    v_lshrrev_b32 v11, 3, v1
    v_and_b32 v9, 7, v1
    v_bfe_u32 v10, v11, 1, 2
    v_lshlrev_b32 v10, 1, v10
    v_xor_b32 v9, v9, v10
    v_lshlrev_b32 v9, 4, v9
    s_movk_i32 s53, 6144
    v_mul_lo_u32 v11, v11, s53
    v_add_u32 v11, v11, v9
    s_lshl_b32 s53, s53, 3
    s_cmp_eq_u32 s62, 1
    s_cbranch_scc0 L_svc_w4
    s_cmp_eq_u32 s54, 1
    s_cbranch_scc1 L_w5_touch
    s_sub_u32 s49, s5, 20
    s_cmp_lt_u32 s49, 8
    s_cbranch_scc0 L_svc_w5
L_w5_pf:
    s_getpc_b64 s[58:59]
L_pc:
    s_sub_u32 s58, s58, L_pc-adaLN_cond__sliding_block_cached__glu_gated_bilinear__decode_kernel
    s_subb_u32 s59, s59, 0
    v_mov_b32 v4, v5
    global_load_dwordx4 v[200:203], v4, s[58:59] offset:0
    global_load_dwordx4 v[200:203], v4, s[58:59] offset:1024
    global_load_dwordx4 v[200:203], v4, s[58:59] offset:2048
    global_load_dwordx4 v[200:203], v4, s[58:59] offset:3072
    v_add_u32 v4, 4096, v4
    global_load_dwordx4 v[200:203], v4, s[58:59] offset:0
    global_load_dwordx4 v[200:203], v4, s[58:59] offset:1024
    global_load_dwordx4 v[200:203], v4, s[58:59] offset:2048
    global_load_dwordx4 v[200:203], v4, s[58:59] offset:3072
    v_add_u32 v4, 4096, v4
    global_load_dwordx4 v[200:203], v4, s[58:59] offset:0
    global_load_dwordx4 v[200:203], v4, s[58:59] offset:1024
    global_load_dwordx4 v[200:203], v4, s[58:59] offset:2048
    global_load_dwordx4 v[200:203], v4, s[58:59] offset:3072
    v_add_u32 v4, 4096, v4
    global_load_dwordx4 v[200:203], v4, s[58:59] offset:0
    global_load_dwordx4 v[200:203], v4, s[58:59] offset:1024
    global_load_dwordx4 v[200:203], v4, s[58:59] offset:2048
    global_load_dwordx4 v[200:203], v4, s[58:59] offset:3072
    v_add_u32 v4, 4096, v4
    global_load_dwordx4 v[200:203], v4, s[58:59] offset:0
    global_load_dwordx4 v[200:203], v4, s[58:59] offset:1024
    global_load_dwordx4 v[200:203], v4, s[58:59] offset:2048
    s_waitcnt vmcnt(0)
L_w5_touch:
    s_endpgm
L_svc_w4:
    v_mov_b32 v12, -1
    v_mov_b32 v13, -1
    v_mov_b32 v14, -1
    v_mov_b32 v15, -1
    s_lshl_b32 s56, s6, 3
    s_add_u32 s56, s56, s4
    s_lshl_b32 s49, s56, 4
    s_add_u32 s49, s49, s7
    s_lshl_b32 s49, s49, 10
    s_add_u32 s49, s49, 65536
    v_add_u32 v6, s49, v5
    s_lshl_b32 s49, s56, 9
    s_lshl_b32 s50, s7, 3
    s_add_u32 s49, s49, s50
    s_add_u32 s49, s49, 327680
    v_lshlrev_b32 v7, 7, v1
    v_add_u32 v7, s49, v7
    s_waitcnt lgkmcnt(0)
    s_load_dword s44, s[42:43], 0
    s_mov_b32 s8, s42
    s_mov_b32 s9, s43
    s_mov_b32 s10, 2097152
    s_mov_b32 s11, 0x20000
    buffer_store_dwordx4 v[12:15], v6, s[8:11], 0 offen sc1
    s_mov_b64 exec, 0xf
    buffer_store_dwordx2 v[12:13], v7, s[8:11], 0 offen sc1
    s_mov_b64 exec, -1
    s_cmp_eq_u32 s63, 1
    s_cbranch_scc1 L_clr_pm
    s_sub_u32 s49, s5, 12
    s_cmp_lt_u32 s49, 8
    s_cbranch_scc1 L_clr_t1
    s_sub_u32 s49, s5, 4
    s_cmp_lt_u32 s49, 7
    s_cbranch_scc0 L_clr_done
    s_mul_i32 s49, s4, 7
    s_add_u32 s49, s49, s5
    s_sub_u32 s49, s49, 4
    s_lshl_b32 s49, s49, 11
    s_add_u32 s49, s49, 393216
    v_add_u32 v6, s49, v5
    buffer_store_dwordx4 v[12:15], v6, s[8:11], 0 offen sc1
    buffer_store_dwordx4 v[12:15], v6, s[8:11], 0 offen offset:1024 sc1
    s_branch L_clr_done
L_clr_t1:
    s_sub_u32 s49, s5, 12
    s_lshr_b32 s50, s49, 2
    s_and_b32 s49, s49, 3
    s_lshl_b32 s51, s4, 1
    s_add_u32 s50, s50, s51
    s_lshl_b32 s50, s50, 11
    s_lshl_b32 s49, s49, 8
    s_add_u32 s49, s49, s50
    s_add_u32 s49, s49, 344064
    v_lshlrev_b32 v6, 10, v3
    v_lshl_add_u32 v6, v2, 4, v6
    v_add_u32 v6, s49, v6
    s_mov_b32 exec_hi, 0
    buffer_store_dwordx4 v[12:15], v6, s[8:11], 0 offen sc1
    s_mov_b64 exec, -1
    s_branch L_clr_done
L_clr_pm:
    s_sub_u32 s49, s5, 28
    s_lshl_b32 s49, s49, 11
    s_lshl_b32 s50, s4, 7
    s_add_u32 s49, s49, s50
    s_add_u32 s49, s49, 49152
    v_lshrrev_b32 v6, 3, v1
    v_lshlrev_b32 v6, 10, v6
    v_and_b32 v7, 7, v1
    v_lshl_add_u32 v6, v7, 4, v6
    v_add_u32 v6, s49, v6
    s_mov_b64 exec, 0xffff
    buffer_store_dwordx4 v[12:15], v6, s[8:11], 0 offen sc1
    s_mov_b64 exec, -1
L_clr_done:
    s_branch L_svc_dma
L_svc_w5:
    s_waitcnt lgkmcnt(0)
    s_load_dword s44, s[42:43], 0
    s_mov_b32 s8, s42
    s_mov_b32 s9, s43
    s_mov_b32 s10, 2097152
    s_mov_b32 s11, 0x20000
    s_sub_u32 s49, s5, 12
    s_cmp_lt_u32 s49, 8
    s_cbranch_scc1 L_svc_tail
L_svc_dma:
    s_mov_b32 s52, 0
    s_cmp_eq_u32 s61, 1
    s_cbranch_scc0 L_svc_nodma
    s_mov_b32 s12, s36
    s_mov_b32 s13, s37
    s_mov_b32 s14, 3145728
    s_mov_b32 s15, 0x20000
    s_lshl_b32 s49, s62, 10
    v_add_u32 v8, s49, v5
    global_load_dwordx4 v[20:23], v8, s[34:35]
    s_sub_u32 s49, s5, 28
    s_lshl_b32 s49, s49, 3
    s_add_u32 s49, s49, s4
    s_lshl_b32 s49, s49, 7
    s_add_u32 s49, s49, 2048
    s_lshl_b32 s50, s53, 5
    s_mul_i32 s50, s50, s62
    s_add_u32 s50, s50, s49
    s_lshl_b32 s51, s62, 15
    s_mov_b32 s52, 32
L_svc_dma_go:
    s_mov_b32 s57, s52
L_svd_loop:
    s_mov_b32 m0, s51
    s_add_u32 s51, s51, 1024
    buffer_load_dwordx4 v11, s[12:15], s50 offen nt lds
    s_add_u32 s50, s50, s53
    s_sub_u32 s57, s57, 1
    s_cmp_lg_u32 s57, 0
    s_cbranch_scc1 L_svd_loop
L_svc_nodma:
    s_cmp_eq_u32 s55, 1
    s_cbranch_scc0 L_svc_nopq
    s_waitcnt lgkmcnt(0)
    s_mul_i32 s44, s44, 0x41c64e6d
    s_add_u32 s44, s44, 12345
    s_branch L_svq
L_svc_nopq:
    s_cmp_eq_u32 s62, 1
    s_cbranch_scc1 L_svc_bar0
    s_lshl_b32 s49, s2, 2
    s_add_u32 s49, s49, 4096
    v_mov_b32 v6, s49
    s_cmp_eq_u32 s52, 0
    s_cbranch_scc1 L_w0
    s_waitcnt vmcnt(33) lgkmcnt(0)
    s_branch L_wdone
L_w0:
    s_waitcnt vmcnt(0) lgkmcnt(0)
L_wdone:
    s_mul_i32 s44, s44, 0x41c64e6d
    s_add_u32 s44, s44, 12345
    v_mov_b32 v7, s44
    s_mov_b64 exec, 1
    buffer_store_dword v7, v6, s[8:11], 0 offen sc1
    s_mov_b64 exec, -1
L_w4_bar:
    s_barrier
    s_branch L_svc_go
L_svc_bar0:
    s_waitcnt lgkmcnt(0)
    s_mul_i32 s44, s44, 0x41c64e6d
    s_add_u32 s44, s44, 12345
    s_barrier
    s_branch L_svc_go
L_bulk:
    s_sub_u32 s46, s7, 6
    s_mul_i32 s46, s46, 5
    s_add_u32 s46, s46, 16
    s_cmp_lt_u32 s5, 20
    s_cbranch_scc1 L_bulk_nt5
    s_sub_u32 s46, s7, 10
    s_mul_i32 s46, s46, 5
    s_add_u32 s46, s46, 36
    s_cmp_lt_u32 s5, 28
    s_cbranch_scc1 L_bulk_nt5
    s_sub_u32 s46, s7, 14
    s_mul_i32 s46, s46, 4
    s_add_u32 s46, s46, 56
    s_branch L_bulk_nt4
L_bulk_nt4:
    s_lshl_b32 s46, s46, 6
    s_mul_i32 s47, s3, 64
    s_add_u32 s46, s46, s47
    s_lshl_b32 s46, s46, 8
    s_lshl_b32 s45, s6, 3
    s_add_u32 s45, s45, s4
    s_lshl_b32 s45, s45, 23
    s_add_u32 s45, s45, s46
    s_add_u32 s45, s45, 7344128
    v_lshlrev_b32 v4, 8, v2
    v_lshl_add_u32 v4, v3, 4, v4
    v_add_u32 v4, s45, v4
    v_lshlrev_b32 v233, 4, v2
    v_lshl_add_u32 v233, v3, 10, v233
    v_add_u32 v233, s45, v233
    v_add_u32 v5, 8192, v4
    v_add_u32 v234, 8192, v233
    s_waitcnt lgkmcnt(0)
    s_barrier
    global_load_dwordx4 v[16:19], v4, s[18:19] offset:-4096 nt
    global_load_dwordx4 v[20:23], v4, s[18:19] offset:-4032 nt
    global_load_dwordx4 v[24:27], v4, s[18:19] offset:-3968 nt
    global_load_dwordx4 v[28:31], v4, s[18:19] offset:-3904 nt
    global_load_dwordx4 v[32:35], v4, s[18:19] offset:0 nt
    global_load_dwordx4 v[36:39], v4, s[18:19] offset:64 nt
    global_load_dwordx4 v[40:43], v4, s[18:19] offset:128 nt
    global_load_dwordx4 v[44:47], v4, s[18:19] offset:192 nt
    global_load_dwordx4 v[48:51], v5, s[18:19] offset:-4096 nt
    global_load_dwordx4 v[52:55], v5, s[18:19] offset:-4032 nt
    global_load_dwordx4 v[56:59], v5, s[18:19] offset:-3968 nt
    global_load_dwordx4 v[60:63], v5, s[18:19] offset:-3904 nt
    global_load_dwordx4 v[64:67], v5, s[18:19] offset:0 nt
    global_load_dwordx4 v[68:71], v5, s[18:19] offset:64 nt
    global_load_dwordx4 v[72:75], v5, s[18:19] offset:128 nt
    global_load_dwordx4 v[76:79], v5, s[18:19] offset:192 nt
    global_load_dwordx4 v[96:99], v233, s[20:21] offset:-4096 nt
    global_load_dwordx4 v[100:103], v233, s[20:21] offset:-3840 nt
    global_load_dwordx4 v[104:107], v233, s[20:21] offset:-3584 nt
    global_load_dwordx4 v[108:111], v233, s[20:21] offset:-3328 nt
    global_load_dwordx4 v[112:115], v233, s[20:21] offset:0 nt
    global_load_dwordx4 v[116:119], v233, s[20:21] offset:256 nt
    global_load_dwordx4 v[120:123], v233, s[20:21] offset:512 nt
    global_load_dwordx4 v[124:127], v233, s[20:21] offset:768 nt
    global_load_dwordx4 v[128:131], v234, s[20:21] offset:-4096 nt
    global_load_dwordx4 v[132:135], v234, s[20:21] offset:-3840 nt
    global_load_dwordx4 v[136:139], v234, s[20:21] offset:-3584 nt
    global_load_dwordx4 v[140:143], v234, s[20:21] offset:-3328 nt
    global_load_dwordx4 v[144:147], v234, s[20:21] offset:0 nt
    global_load_dwordx4 v[148:151], v234, s[20:21] offset:256 nt
    global_load_dwordx4 v[152:155], v234, s[20:21] offset:512 nt
    global_load_dwordx4 v[156:159], v234, s[20:21] offset:768 nt
    s_lshl_b32 s57, s3, 2
    s_add_u32 s57, s57, 142704
    v_mov_b32 v10, s57
    v_mov_b32 v11, 1
    s_mov_b64 exec, 1
    ds_write_b32 v10, v11
    s_mov_b64 exec, -1
    s_branch L_att4
L_bulk_nt5:
    s_lshl_b32 s46, s46, 6
    s_mul_i32 s47, s3, 80
    s_add_u32 s46, s46, s47
    s_lshl_b32 s46, s46, 8
    s_lshl_b32 s45, s6, 3
    s_add_u32 s45, s45, s4
    s_lshl_b32 s45, s45, 23
    s_add_u32 s45, s45, s46
    s_add_u32 s45, s45, 7344128
    v_lshlrev_b32 v4, 8, v2
    v_lshl_add_u32 v4, v3, 4, v4
    v_add_u32 v4, s45, v4
    v_lshlrev_b32 v233, 4, v2
    v_lshl_add_u32 v233, v3, 10, v233
    v_add_u32 v233, s45, v233
    v_add_u32 v5, 8192, v4
    v_add_u32 v234, 8192, v233
    v_add_u32 v6, 16384, v4
    v_add_u32 v235, 16384, v233
    s_waitcnt lgkmcnt(0)
    s_barrier
    global_load_dwordx4 v[16:19], v4, s[18:19] offset:-4096 nt
    global_load_dwordx4 v[20:23], v4, s[18:19] offset:-4032 nt
    global_load_dwordx4 v[24:27], v4, s[18:19] offset:-3968 nt
    global_load_dwordx4 v[28:31], v4, s[18:19] offset:-3904 nt
    global_load_dwordx4 v[32:35], v4, s[18:19] offset:0 nt
    global_load_dwordx4 v[36:39], v4, s[18:19] offset:64 nt
    global_load_dwordx4 v[40:43], v4, s[18:19] offset:128 nt
    global_load_dwordx4 v[44:47], v4, s[18:19] offset:192 nt
    global_load_dwordx4 v[48:51], v5, s[18:19] offset:-4096 nt
    global_load_dwordx4 v[52:55], v5, s[18:19] offset:-4032 nt
    global_load_dwordx4 v[56:59], v5, s[18:19] offset:-3968 nt
    global_load_dwordx4 v[60:63], v5, s[18:19] offset:-3904 nt
    global_load_dwordx4 v[64:67], v5, s[18:19] offset:0 nt
    global_load_dwordx4 v[68:71], v5, s[18:19] offset:64 nt
    global_load_dwordx4 v[72:75], v5, s[18:19] offset:128 nt
    global_load_dwordx4 v[76:79], v5, s[18:19] offset:192 nt
    global_load_dwordx4 v[80:83], v6, s[18:19] offset:-4096 nt
    global_load_dwordx4 v[84:87], v6, s[18:19] offset:-4032 nt
    global_load_dwordx4 v[88:91], v6, s[18:19] offset:-3968 nt
    global_load_dwordx4 v[92:95], v6, s[18:19] offset:-3904 nt
    global_load_dwordx4 v[96:99], v233, s[20:21] offset:-4096 nt
    global_load_dwordx4 v[100:103], v233, s[20:21] offset:-3840 nt
    global_load_dwordx4 v[104:107], v233, s[20:21] offset:-3584 nt
    global_load_dwordx4 v[108:111], v233, s[20:21] offset:-3328 nt
    global_load_dwordx4 v[112:115], v233, s[20:21] offset:0 nt
    global_load_dwordx4 v[116:119], v233, s[20:21] offset:256 nt
    global_load_dwordx4 v[120:123], v233, s[20:21] offset:512 nt
    global_load_dwordx4 v[124:127], v233, s[20:21] offset:768 nt
    global_load_dwordx4 v[128:131], v234, s[20:21] offset:-4096 nt
    global_load_dwordx4 v[132:135], v234, s[20:21] offset:-3840 nt
    global_load_dwordx4 v[136:139], v234, s[20:21] offset:-3584 nt
    global_load_dwordx4 v[140:143], v234, s[20:21] offset:-3328 nt
    global_load_dwordx4 v[144:147], v234, s[20:21] offset:0 nt
    global_load_dwordx4 v[148:151], v234, s[20:21] offset:256 nt
    global_load_dwordx4 v[152:155], v234, s[20:21] offset:512 nt
    global_load_dwordx4 v[156:159], v234, s[20:21] offset:768 nt
    global_load_dwordx4 v[160:163], v235, s[20:21] offset:-4096 nt
    global_load_dwordx4 v[164:167], v235, s[20:21] offset:-3840 nt
    global_load_dwordx4 v[168:171], v235, s[20:21] offset:-3584 nt
    global_load_dwordx4 v[172:175], v235, s[20:21] offset:-3328 nt
    s_lshl_b32 s57, s3, 2
    s_add_u32 s57, s57, 142704
    v_mov_b32 v10, s57
    v_mov_b32 v11, 1
    s_mov_b64 exec, 1
    ds_write_b32 v10, v11
    s_mov_b64 exec, -1
    s_branch L_att5
L_pq_rest:
    s_load_dword s44, s[42:43], 0
    s_mov_b32 s8, s42
    s_mov_b32 s9, s43
    s_mov_b32 s10, 2097152
    s_mov_b32 s11, 0x20000
    s_lshl_b32 s49, s3, 1
    v_lshrrev_b32 v12, 2, v1
    v_bfe_u32 v17, v12, 1, 2
    v_lshlrev_b32 v17, 1, v17
    v_xor_b32 v17, s49, v17
    v_bfe_u32 v13, v1, 1, 1
    v_add_u32 v17, v17, v13
    v_lshlrev_b32 v17, 4, v17
    v_and_b32 v13, 1, v1
    v_lshl_add_u32 v17, v13, 3, v17
    v_lshl_add_u32 v17, v12, 7, v17
    v_and_b32 v18, 1, v1
    v_mul_u32_u24 v18, 1040, v18
    v_lshl_add_u32 v18, v3, 3, v18
    v_add_u32 v18, 131072, v18
    s_lshl_b32 s49, s48, 8
    s_lshl_b32 s50, s3, 6
    s_add_u32 s49, s49, s50
    s_lshl_b32 s50, s4, 11
    s_add_u32 s49, s49, s50
    s_add_u32 s49, s49, 16384
    v_and_b32 v19, 1, v1
    v_lshlrev_b32 v19, 14, v19
    v_lshl_add_u32 v19, v3, 4, v19
    v_add_u32 v19, s49, v19
    s_waitcnt vmcnt(0) lgkmcnt(0)
    s_mul_i32 s44, s44, 0x41c64e6d
    s_add_u32 s44, s44, 12345
    v_mov_b32 v29, s44
    v_mov_b32 v31, s44
    s_lshl_b32 s57, s3, 2
    s_add_u32 s57, s57, 142704
    v_mov_b32 v26, s57
    v_mov_b32 v27, 1
    s_mov_b64 exec, 1
    ds_write_b32 v26, v27
    s_mov_b64 exec, -1
    v_mov_b32 v232, 142704
    s_mov_b32 s46, 1
    s_mov_b32 s47, 0
L_pq_wa:
    ds_read_b128 v[228:231], v232
    s_add_u32 s47, s47, 1
    s_waitcnt lgkmcnt(0)
    v_xor_b32 v228, s46, v228
    v_xor_b32 v229, s46, v229
    v_xor_b32 v230, s46, v230
    v_xor_b32 v231, s46, v231
    v_or3_b32 v228, v228, v229, v230
    v_or_b32 v228, v228, v231
    v_cmp_ne_u32 vcc, 0, v228
    s_cmp_ge_u32 s47, 320000
    s_cbranch_scc1 L_pq_wa_x
    s_cbranch_vccnz L_pq_wa
L_pq_wa_x:
    ds_read_b64_tr_b16 v[32:33], v17 offset:0
    ds_read_b64_tr_b16 v[34:35], v17 offset:2048
    ds_read_b64_tr_b16 v[36:37], v17 offset:4096
    ds_read_b64_tr_b16 v[38:39], v17 offset:6144
    ds_read_b64_tr_b16 v[40:41], v17 offset:8192
    ds_read_b64_tr_b16 v[42:43], v17 offset:10240
    ds_read_b64_tr_b16 v[44:45], v17 offset:12288
    ds_read_b64_tr_b16 v[46:47], v17 offset:14336
    ds_read_b64_tr_b16 v[48:49], v17 offset:16384
    ds_read_b64_tr_b16 v[50:51], v17 offset:18432
    ds_read_b64_tr_b16 v[52:53], v17 offset:20480
    ds_read_b64_tr_b16 v[54:55], v17 offset:22528
    ds_read_b64_tr_b16 v[56:57], v17 offset:24576
    ds_read_b64_tr_b16 v[58:59], v17 offset:26624
    s_waitcnt lgkmcnt(6)
    ds_read_b64_tr_b16 v[60:61], v17 offset:28672
    ds_read_b64_tr_b16 v[62:63], v17 offset:30720
    ds_read_b64_tr_b16 v[64:65], v17 offset:32768
    ds_read_b64_tr_b16 v[66:67], v17 offset:34816
    ds_read_b64_tr_b16 v[68:69], v17 offset:36864
    ds_read_b64_tr_b16 v[70:71], v17 offset:38912
    ds_read_b64_tr_b16 v[72:73], v17 offset:40960
    ds_read_b64_tr_b16 v[74:75], v17 offset:43008
    s_waitcnt lgkmcnt(6)
    ds_read_b64_tr_b16 v[76:77], v17 offset:45056
    ds_read_b64_tr_b16 v[78:79], v17 offset:47104
    ds_read_b64_tr_b16 v[80:81], v17 offset:49152
    ds_read_b64_tr_b16 v[82:83], v17 offset:51200
    ds_read_b64_tr_b16 v[84:85], v17 offset:53248
    ds_read_b64_tr_b16 v[86:87], v17 offset:55296
    ds_read_b64_tr_b16 v[88:89], v17 offset:57344
    ds_read_b64_tr_b16 v[90:91], v17 offset:59392
    s_waitcnt lgkmcnt(6)
    ds_read_b64_tr_b16 v[92:93], v17 offset:61440
    ds_read_b64_tr_b16 v[94:95], v17 offset:63488
    s_waitcnt lgkmcnt(0)
    s_barrier
    ds_read2_b64 v[96:99], v18 offset0:0 offset1:4
    ds_read2_b64 v[100:103], v18 offset0:8 offset1:12
    ds_read2_b64 v[104:107], v18 offset0:16 offset1:20
    ds_read2_b64 v[108:111], v18 offset0:24 offset1:28
    ds_read2_b64 v[112:115], v18 offset0:32 offset1:36
    ds_read2_b64 v[116:119], v18 offset0:40 offset1:44
    ds_read2_b64 v[120:123], v18 offset0:48 offset1:52
    ds_read2_b64 v[124:127], v18 offset0:56 offset1:60
    ds_read2_b64 v[128:131], v18 offset0:64 offset1:68
    ds_read2_b64 v[132:135], v18 offset0:72 offset1:76
    ds_read2_b64 v[136:139], v18 offset0:80 offset1:84
    ds_read2_b64 v[140:143], v18 offset0:88 offset1:92
    ds_read2_b64 v[144:147], v18 offset0:96 offset1:100
    ds_read2_b64 v[148:151], v18 offset0:104 offset1:108
    ds_read2_b64 v[152:155], v18 offset0:112 offset1:116
    s_waitcnt lgkmcnt(14)
    v_mfma_f32_16x16x32_bf16 v[24:27], v[32:35], v[96:99], 0
    ds_read2_b64 v[156:159], v18 offset0:120 offset1:124
    s_waitcnt lgkmcnt(14)
    v_mfma_f32_16x16x32_bf16 v[24:27], v[36:39], v[100:103], v[24:27]
    s_waitcnt lgkmcnt(13)
    v_mfma_f32_16x16x32_bf16 v[24:27], v[40:43], v[104:107], v[24:27]
    s_waitcnt lgkmcnt(12)
    v_mfma_f32_16x16x32_bf16 v[24:27], v[44:47], v[108:111], v[24:27]
    s_waitcnt lgkmcnt(11)
    v_mfma_f32_16x16x32_bf16 v[24:27], v[48:51], v[112:115], v[24:27]
    s_waitcnt lgkmcnt(10)
    v_mfma_f32_16x16x32_bf16 v[24:27], v[52:55], v[116:119], v[24:27]
    s_waitcnt lgkmcnt(9)
    v_mfma_f32_16x16x32_bf16 v[24:27], v[56:59], v[120:123], v[24:27]
    s_waitcnt lgkmcnt(8)
    v_mfma_f32_16x16x32_bf16 v[24:27], v[60:63], v[124:127], v[24:27]
    s_waitcnt lgkmcnt(7)
    v_mfma_f32_16x16x32_bf16 v[24:27], v[64:67], v[128:131], v[24:27]
    s_waitcnt lgkmcnt(6)
    v_mfma_f32_16x16x32_bf16 v[24:27], v[68:71], v[132:135], v[24:27]
    s_waitcnt lgkmcnt(5)
    v_mfma_f32_16x16x32_bf16 v[24:27], v[72:75], v[136:139], v[24:27]
    s_waitcnt lgkmcnt(4)
    v_mfma_f32_16x16x32_bf16 v[24:27], v[76:79], v[140:143], v[24:27]
    s_waitcnt lgkmcnt(3)
    v_mfma_f32_16x16x32_bf16 v[24:27], v[80:83], v[144:147], v[24:27]
    s_waitcnt lgkmcnt(2)
    v_mfma_f32_16x16x32_bf16 v[24:27], v[84:87], v[148:151], v[24:27]
    s_waitcnt lgkmcnt(1)
    v_mfma_f32_16x16x32_bf16 v[24:27], v[88:91], v[152:155], v[24:27]
    s_waitcnt lgkmcnt(0)
    v_mfma_f32_16x16x32_bf16 v[24:27], v[92:95], v[156:159], v[24:27]
    s_nop 7
    v_cvt_pk_bf16_f32 v28, v24, v25
    v_cvt_pk_bf16_f32 v30, v26, v27
    s_mov_b32 exec_lo, 0x00030003
    s_mov_b32 exec_hi, 0x00030003
    buffer_store_dwordx4 v[28:31], v19, s[8:11], 0 offen sc1
    s_mov_b64 exec, -1
    s_lshl_b32 s57, s3, 2
    s_add_u32 s57, s57, 142720
    v_mov_b32 v10, s57
    v_mov_b32 v11, 1
    s_mov_b64 exec, 1
    ds_write_b32 v10, v11
    s_mov_b64 exec, -1
    s_setprio 0
    s_sub_u32 s46, s7, 2
    s_mul_i32 s46, s46, 2
    s_add_u32 s46, s46, 8
    s_lshl_b32 s46, s46, 6
    s_mul_i32 s47, s3, 32
    s_add_u32 s46, s46, s47
    s_lshl_b32 s46, s46, 8
    s_lshl_b32 s45, s6, 3
    s_add_u32 s45, s45, s4
    s_lshl_b32 s45, s45, 23
    s_add_u32 s45, s45, s46
    s_add_u32 s45, s45, 7344128
    v_lshlrev_b32 v4, 8, v2
    v_lshl_add_u32 v4, v3, 4, v4
    v_add_u32 v4, s45, v4
    v_lshlrev_b32 v233, 4, v2
    v_lshl_add_u32 v233, v3, 10, v233
    v_add_u32 v233, s45, v233
    global_load_dwordx4 v[16:19], v4, s[18:19] offset:-4096 nt
    global_load_dwordx4 v[20:23], v4, s[18:19] offset:-4032 nt
    global_load_dwordx4 v[24:27], v4, s[18:19] offset:-3968 nt
    global_load_dwordx4 v[28:31], v4, s[18:19] offset:-3904 nt
    global_load_dwordx4 v[32:35], v4, s[18:19] offset:0 nt
    global_load_dwordx4 v[36:39], v4, s[18:19] offset:64 nt
    global_load_dwordx4 v[40:43], v4, s[18:19] offset:128 nt
    global_load_dwordx4 v[44:47], v4, s[18:19] offset:192 nt
    global_load_dwordx4 v[96:99], v233, s[20:21] offset:-4096 nt
    global_load_dwordx4 v[100:103], v233, s[20:21] offset:-3840 nt
    global_load_dwordx4 v[104:107], v233, s[20:21] offset:-3584 nt
    global_load_dwordx4 v[108:111], v233, s[20:21] offset:-3328 nt
    global_load_dwordx4 v[112:115], v233, s[20:21] offset:0 nt
    global_load_dwordx4 v[116:119], v233, s[20:21] offset:256 nt
    global_load_dwordx4 v[120:123], v233, s[20:21] offset:512 nt
    global_load_dwordx4 v[124:127], v233, s[20:21] offset:768 nt
    s_branch L_att2
L_ph_rest:
    s_load_dword s44, s[42:43], 0
    s_mov_b32 s8, s42
    s_mov_b32 s9, s43
    s_mov_b32 s10, 2097152
    s_mov_b32 s11, 0x20000
    s_waitcnt vmcnt(8)
    v_lshlrev_b32 v32, 16, v20
    v_and_b32 v33, 0xffff0000, v20
    v_lshlrev_b32 v34, 16, v21
    v_and_b32 v35, 0xffff0000, v21
    s_mov_b32 s49, 3216550459
    v_mul_f32 v36, s49, v32
    v_mul_f32 v37, s49, v33
    v_mul_f32 v38, s49, v34
    v_mul_f32 v39, s49, v35
    v_exp_f32 v36, v36
    v_exp_f32 v37, v37
    v_exp_f32 v38, v38
    v_exp_f32 v39, v39
    v_add_f32 v36, 1.0, v36
    v_add_f32 v37, 1.0, v37
    v_add_f32 v38, 1.0, v38
    v_add_f32 v39, 1.0, v39
    v_rcp_f32 v36, v36
    v_rcp_f32 v37, v37
    v_rcp_f32 v38, v38
    v_rcp_f32 v39, v39
    v_mul_f32 v32, v32, v36
    v_mul_f32 v33, v33, v37
    v_mul_f32 v34, v34, v38
    v_mul_f32 v35, v35, v39
    v_cvt_pk_bf16_f32 v32, v32, v33
    v_cvt_pk_bf16_f32 v33, v34, v35
    s_lshr_b32 s49, s3, 1
    s_lshl_b32 s49, s49, 4
    s_add_u32 s49, s49, 131072
    v_add_u32 v36, s49, v8
    ds_write_b64 v36, v[32:33]
    s_lshl_b32 s49, s3, 1
    v_lshrrev_b32 v12, 2, v1
    v_bfe_u32 v17, v12, 1, 2
    v_lshlrev_b32 v17, 1, v17
    v_xor_b32 v17, s49, v17
    v_bfe_u32 v13, v1, 1, 1
    v_add_u32 v17, v17, v13
    v_lshlrev_b32 v17, 4, v17
    v_and_b32 v13, 1, v1
    v_lshl_add_u32 v17, v13, 3, v17
    v_lshl_add_u32 v17, v12, 7, v17
    v_and_b32 v18, 1, v1
    v_mul_u32_u24 v18, 1040, v18
    v_lshl_add_u32 v18, v3, 3, v18
    v_add_u32 v18, 131072, v18
    s_lshl_b32 s49, s6, 9
    v_add_u32 v18, s49, v18
    s_lshl_b32 s49, s6, 13
    s_lshl_b32 s50, s7, 12
    s_add_u32 s49, s49, s50
    s_lshl_b32 s50, s4, 8
    s_add_u32 s49, s49, s50
    s_lshl_b32 s50, s3, 6
    s_add_u32 s49, s49, s50
    s_add_u32 s49, s49, 524288
    v_and_b32 v20, 1, v1
    v_lshlrev_b32 v20, 11, v20
    v_lshl_add_u32 v20, v3, 4, v20
    v_add_u32 v20, s49, v20
    s_waitcnt vmcnt(0) lgkmcnt(0)
    s_mul_i32 s44, s44, 0x41c64e6d
    s_add_u32 s44, s44, 12345
    v_mov_b32 v29, s44
    v_mov_b32 v31, s44
    s_barrier
    ds_read_b64_tr_b16 v[32:33], v17 offset:0
    ds_read_b64_tr_b16 v[34:35], v17 offset:2048
    ds_read_b64_tr_b16 v[36:37], v17 offset:4096
    ds_read_b64_tr_b16 v[38:39], v17 offset:6144
    ds_read_b64_tr_b16 v[40:41], v17 offset:8192
    ds_read_b64_tr_b16 v[42:43], v17 offset:10240
    ds_read_b64_tr_b16 v[44:45], v17 offset:12288
    ds_read_b64_tr_b16 v[46:47], v17 offset:14336
    ds_read_b64_tr_b16 v[48:49], v17 offset:16384
    ds_read_b64_tr_b16 v[50:51], v17 offset:18432
    ds_read_b64_tr_b16 v[52:53], v17 offset:20480
    ds_read_b64_tr_b16 v[54:55], v17 offset:22528
    ds_read_b64_tr_b16 v[56:57], v17 offset:24576
    ds_read_b64_tr_b16 v[58:59], v17 offset:26624
    s_waitcnt lgkmcnt(6)
    ds_read_b64_tr_b16 v[60:61], v17 offset:28672
    ds_read_b64_tr_b16 v[62:63], v17 offset:30720
    s_waitcnt lgkmcnt(0)
    ds_read2_b64 v[64:67], v18 offset0:0 offset1:4
    ds_read2_b64 v[68:71], v18 offset0:8 offset1:12
    ds_read2_b64 v[72:75], v18 offset0:16 offset1:20
    ds_read2_b64 v[76:79], v18 offset0:24 offset1:28
    ds_read2_b64 v[80:83], v18 offset0:32 offset1:36
    ds_read2_b64 v[84:87], v18 offset0:40 offset1:44
    ds_read2_b64 v[88:91], v18 offset0:48 offset1:52
    ds_read2_b64 v[92:95], v18 offset0:56 offset1:60
    s_waitcnt lgkmcnt(7)
    v_mfma_f32_16x16x32_bf16 v[24:27], v[32:35], v[64:67], 0
    s_waitcnt lgkmcnt(6)
    v_mfma_f32_16x16x32_bf16 v[24:27], v[36:39], v[68:71], v[24:27]
    s_waitcnt lgkmcnt(5)
    v_mfma_f32_16x16x32_bf16 v[24:27], v[40:43], v[72:75], v[24:27]
    s_waitcnt lgkmcnt(4)
    v_mfma_f32_16x16x32_bf16 v[24:27], v[44:47], v[76:79], v[24:27]
    s_waitcnt lgkmcnt(3)
    v_mfma_f32_16x16x32_bf16 v[24:27], v[48:51], v[80:83], v[24:27]
    s_waitcnt lgkmcnt(2)
    v_mfma_f32_16x16x32_bf16 v[24:27], v[52:55], v[84:87], v[24:27]
    s_waitcnt lgkmcnt(1)
    v_mfma_f32_16x16x32_bf16 v[24:27], v[56:59], v[88:91], v[24:27]
    s_waitcnt lgkmcnt(0)
    v_mfma_f32_16x16x32_bf16 v[24:27], v[60:63], v[92:95], v[24:27]
    s_nop 7
    v_cvt_pk_bf16_f32 v28, v24, v25
    v_cvt_pk_bf16_f32 v30, v26, v27
    s_mov_b32 exec_lo, 0x00030003
    s_mov_b32 exec_hi, 0x00030003
    buffer_store_dwordx4 v[28:31], v20, s[8:11], 0 offen sc1
    s_mov_b64 exec, -1
    s_setprio 0
    s_mul_i32 s46, s7, 256
    s_mul_i32 s47, s3, 64
    s_add_u32 s46, s46, s47
    s_lshl_b32 s46, s46, 8
    s_lshl_b32 s45, s6, 3
    s_add_u32 s45, s45, s4
    s_lshl_b32 s45, s45, 23
    s_add_u32 s45, s45, s46
    s_add_u32 s45, s45, 7344128
    v_lshlrev_b32 v4, 8, v2
    v_lshl_add_u32 v4, v3, 4, v4
    v_add_u32 v4, s45, v4
    v_lshlrev_b32 v233, 4, v2
    v_lshl_add_u32 v233, v3, 10, v233
    v_add_u32 v233, s45, v233
    v_add_u32 v5, 8192, v4
    v_add_u32 v234, 8192, v233
    global_load_dwordx4 v[16:19], v4, s[18:19] offset:-4096 nt
    global_load_dwordx4 v[20:23], v4, s[18:19] offset:-4032 nt
    global_load_dwordx4 v[24:27], v4, s[18:19] offset:-3968 nt
    global_load_dwordx4 v[28:31], v4, s[18:19] offset:-3904 nt
    global_load_dwordx4 v[32:35], v4, s[18:19] offset:0 nt
    global_load_dwordx4 v[36:39], v4, s[18:19] offset:64 nt
    global_load_dwordx4 v[40:43], v4, s[18:19] offset:128 nt
    global_load_dwordx4 v[44:47], v4, s[18:19] offset:192 nt
    global_load_dwordx4 v[48:51], v5, s[18:19] offset:-4096 nt
    global_load_dwordx4 v[52:55], v5, s[18:19] offset:-4032 nt
    global_load_dwordx4 v[56:59], v5, s[18:19] offset:-3968 nt
    global_load_dwordx4 v[60:63], v5, s[18:19] offset:-3904 nt
    global_load_dwordx4 v[64:67], v5, s[18:19] offset:0 nt
    global_load_dwordx4 v[68:71], v5, s[18:19] offset:64 nt
    global_load_dwordx4 v[72:75], v5, s[18:19] offset:128 nt
    global_load_dwordx4 v[76:79], v5, s[18:19] offset:192 nt
    global_load_dwordx4 v[96:99], v233, s[20:21] offset:-4096 nt
    global_load_dwordx4 v[100:103], v233, s[20:21] offset:-3840 nt
    global_load_dwordx4 v[104:107], v233, s[20:21] offset:-3584 nt
    global_load_dwordx4 v[108:111], v233, s[20:21] offset:-3328 nt
    global_load_dwordx4 v[112:115], v233, s[20:21] offset:0 nt
    global_load_dwordx4 v[116:119], v233, s[20:21] offset:256 nt
    global_load_dwordx4 v[120:123], v233, s[20:21] offset:512 nt
    global_load_dwordx4 v[124:127], v233, s[20:21] offset:768 nt
    global_load_dwordx4 v[128:131], v234, s[20:21] offset:-4096 nt
    global_load_dwordx4 v[132:135], v234, s[20:21] offset:-3840 nt
    global_load_dwordx4 v[136:139], v234, s[20:21] offset:-3584 nt
    global_load_dwordx4 v[140:143], v234, s[20:21] offset:-3328 nt
    global_load_dwordx4 v[144:147], v234, s[20:21] offset:0 nt
    global_load_dwordx4 v[148:151], v234, s[20:21] offset:256 nt
    global_load_dwordx4 v[152:155], v234, s[20:21] offset:512 nt
    global_load_dwordx4 v[156:159], v234, s[20:21] offset:768 nt
    s_branch L_att4
L_svc_go:
    s_cmp_eq_u32 s61, 1
    s_cbranch_scc0 L_svc_nonp
    s_waitcnt vmcnt(32)
    s_mov_b32 s49, 3216550459
    v_lshlrev_b32 v32, 16, v20
    v_and_b32 v33, 0xffff0000, v20
    v_lshlrev_b32 v34, 16, v21
    v_and_b32 v35, 0xffff0000, v21
    v_lshlrev_b32 v36, 16, v22
    v_and_b32 v37, 0xffff0000, v22
    v_lshlrev_b32 v38, 16, v23
    v_and_b32 v39, 0xffff0000, v23
    v_mul_f32 v40, s49, v32
    v_mul_f32 v41, s49, v33
    v_mul_f32 v42, s49, v34
    v_mul_f32 v43, s49, v35
    v_mul_f32 v44, s49, v36
    v_mul_f32 v45, s49, v37
    v_mul_f32 v46, s49, v38
    v_mul_f32 v47, s49, v39
    v_exp_f32 v40, v40
    v_exp_f32 v41, v41
    v_exp_f32 v42, v42
    v_exp_f32 v43, v43
    v_exp_f32 v44, v44
    v_exp_f32 v45, v45
    v_exp_f32 v46, v46
    v_exp_f32 v47, v47
    v_add_f32 v40, 1.0, v40
    v_add_f32 v41, 1.0, v41
    v_add_f32 v42, 1.0, v42
    v_add_f32 v43, 1.0, v43
    v_add_f32 v44, 1.0, v44
    v_add_f32 v45, 1.0, v45
    v_add_f32 v46, 1.0, v46
    v_add_f32 v47, 1.0, v47
    v_rcp_f32 v40, v40
    v_rcp_f32 v41, v41
    v_rcp_f32 v42, v42
    v_rcp_f32 v43, v43
    v_rcp_f32 v44, v44
    v_rcp_f32 v45, v45
    v_rcp_f32 v46, v46
    v_rcp_f32 v47, v47
    v_mul_f32 v32, v32, v40
    v_mul_f32 v33, v33, v41
    v_mul_f32 v34, v34, v42
    v_mul_f32 v35, v35, v43
    v_mul_f32 v36, v36, v44
    v_mul_f32 v37, v37, v45
    v_mul_f32 v38, v38, v46
    v_mul_f32 v39, v39, v47
    v_cvt_pk_bf16_f32 v24, v32, v33
    v_cvt_pk_bf16_f32 v25, v34, v35
    v_cvt_pk_bf16_f32 v26, v36, v37
    v_cvt_pk_bf16_f32 v27, v38, v39
    s_mul_i32 s49, s62, 1040
    s_add_u32 s49, s49, 131072
    v_add_u32 v8, s49, v5
    ds_write_b128 v8, v[24:27]
    s_lshl_b32 s49, s62, 2
    v_lshrrev_b32 v12, 2, v1
    v_bfe_u32 v17, v12, 1, 2
    v_lshlrev_b32 v17, 1, v17
    v_xor_b32 v17, s49, v17
    v_bfe_u32 v13, v1, 1, 1
    v_add_u32 v17, v17, v13
    v_lshlrev_b32 v17, 4, v17
    v_and_b32 v13, 1, v1
    v_lshl_add_u32 v17, v13, 3, v17
    v_lshl_add_u32 v17, v12, 7, v17
    s_add_u32 s49, s49, 2
    v_lshrrev_b32 v12, 2, v1
    v_bfe_u32 v19, v12, 1, 2
    v_lshlrev_b32 v19, 1, v19
    v_xor_b32 v19, s49, v19
    v_bfe_u32 v13, v1, 1, 1
    v_add_u32 v19, v19, v13
    v_lshlrev_b32 v19, 4, v19
    v_and_b32 v13, 1, v1
    v_lshl_add_u32 v19, v13, 3, v19
    v_lshl_add_u32 v19, v12, 7, v19
    v_and_b32 v18, 1, v1
    v_mul_u32_u24 v18, 1040, v18
    v_lshl_add_u32 v18, v3, 3, v18
    v_add_u32 v18, 131072, v18
    s_sub_u32 s49, s5, 28
    s_lshl_b32 s49, s49, 11
    s_lshl_b32 s50, s4, 7
    s_add_u32 s49, s49, s50
    s_lshl_b32 s50, s62, 6
    s_add_u32 s49, s49, s50
    s_add_u32 s49, s49, 49152
    v_and_b32 v20, 1, v1
    v_lshlrev_b32 v20, 10, v20
    v_lshl_add_u32 v20, v3, 3, v20
    v_add_u32 v20, s49, v20
    s_waitcnt vmcnt(0) lgkmcnt(0)
    s_lshl_b32 s49, s62, 2
    s_add_u32 s49, s49, 142664
    v_mov_b32 v28, s49
    v_mov_b32 v29, 1
    s_mov_b64 exec, 1
    ds_write_b32 v28, v29
    s_mov_b64 exec, -1
    v_mov_b32 v30, 142664
    s_mov_b32 s47, 0
L_pm_sync:
    ds_read_b64 v[28:29], v30
    s_add_u32 s47, s47, 1
    s_waitcnt lgkmcnt(0)
    v_and_b32 v28, v28, v29
    v_cmp_ne_u32 vcc, 1, v28
    s_cmp_ge_u32 s47, 320000
    s_cbranch_scc1 L_pm_sync_x
    s_cbranch_vccnz L_pm_sync
L_pm_sync_x:
    ds_read_b64_tr_b16 v[32:33], v17 offset:0
    ds_read_b64_tr_b16 v[34:35], v17 offset:2048
    ds_read_b64_tr_b16 v[36:37], v17 offset:4096
    ds_read_b64_tr_b16 v[38:39], v17 offset:6144
    ds_read_b64_tr_b16 v[40:41], v17 offset:8192
    ds_read_b64_tr_b16 v[42:43], v17 offset:10240
    ds_read_b64_tr_b16 v[44:45], v17 offset:12288
    ds_read_b64_tr_b16 v[46:47], v17 offset:14336
    ds_read_b64_tr_b16 v[48:49], v17 offset:16384
    ds_read_b64_tr_b16 v[50:51], v17 offset:18432
    ds_read_b64_tr_b16 v[52:53], v17 offset:20480
    ds_read_b64_tr_b16 v[54:55], v17 offset:22528
    ds_read_b64_tr_b16 v[56:57], v17 offset:24576
    ds_read_b64_tr_b16 v[58:59], v17 offset:26624
    s_waitcnt lgkmcnt(6)
    ds_read_b64_tr_b16 v[60:61], v17 offset:28672
    ds_read_b64_tr_b16 v[62:63], v17 offset:30720
    ds_read_b64_tr_b16 v[64:65], v17 offset:32768
    ds_read_b64_tr_b16 v[66:67], v17 offset:34816
    ds_read_b64_tr_b16 v[68:69], v17 offset:36864
    ds_read_b64_tr_b16 v[70:71], v17 offset:38912
    ds_read_b64_tr_b16 v[72:73], v17 offset:40960
    ds_read_b64_tr_b16 v[74:75], v17 offset:43008
    s_waitcnt lgkmcnt(6)
    ds_read_b64_tr_b16 v[76:77], v17 offset:45056
    ds_read_b64_tr_b16 v[78:79], v17 offset:47104
    ds_read_b64_tr_b16 v[80:81], v17 offset:49152
    ds_read_b64_tr_b16 v[82:83], v17 offset:51200
    ds_read_b64_tr_b16 v[84:85], v17 offset:53248
    ds_read_b64_tr_b16 v[86:87], v17 offset:55296
    ds_read_b64_tr_b16 v[88:89], v17 offset:57344
    ds_read_b64_tr_b16 v[90:91], v17 offset:59392
    s_waitcnt lgkmcnt(6)
    ds_read_b64_tr_b16 v[92:93], v17 offset:61440
    ds_read_b64_tr_b16 v[94:95], v17 offset:63488
    ds_read_b64_tr_b16 v[96:97], v19 offset:0
    ds_read_b64_tr_b16 v[98:99], v19 offset:2048
    ds_read_b64_tr_b16 v[100:101], v19 offset:4096
    ds_read_b64_tr_b16 v[102:103], v19 offset:6144
    ds_read_b64_tr_b16 v[104:105], v19 offset:8192
    ds_read_b64_tr_b16 v[106:107], v19 offset:10240
    ds_read_b64_tr_b16 v[108:109], v19 offset:12288
    ds_read_b64_tr_b16 v[110:111], v19 offset:14336
    ds_read_b64_tr_b16 v[112:113], v19 offset:16384
    ds_read_b64_tr_b16 v[114:115], v19 offset:18432
    ds_read_b64_tr_b16 v[116:117], v19 offset:20480
    ds_read_b64_tr_b16 v[118:119], v19 offset:22528
    ds_read_b64_tr_b16 v[120:121], v19 offset:24576
    ds_read_b64_tr_b16 v[122:123], v19 offset:26624
    s_waitcnt lgkmcnt(6)
    ds_read_b64_tr_b16 v[124:125], v19 offset:28672
    ds_read_b64_tr_b16 v[126:127], v19 offset:30720
    ds_read_b64_tr_b16 v[128:129], v19 offset:32768
    ds_read_b64_tr_b16 v[130:131], v19 offset:34816
    ds_read_b64_tr_b16 v[132:133], v19 offset:36864
    ds_read_b64_tr_b16 v[134:135], v19 offset:38912
    ds_read_b64_tr_b16 v[136:137], v19 offset:40960
    ds_read_b64_tr_b16 v[138:139], v19 offset:43008
    s_waitcnt lgkmcnt(6)
    ds_read_b64_tr_b16 v[140:141], v19 offset:45056
    ds_read_b64_tr_b16 v[142:143], v19 offset:47104
    ds_read_b64_tr_b16 v[144:145], v19 offset:49152
    ds_read_b64_tr_b16 v[146:147], v19 offset:51200
    ds_read_b64_tr_b16 v[148:149], v19 offset:53248
    ds_read_b64_tr_b16 v[150:151], v19 offset:55296
    ds_read_b64_tr_b16 v[152:153], v19 offset:57344
    ds_read_b64_tr_b16 v[154:155], v19 offset:59392
    s_waitcnt lgkmcnt(6)
    ds_read_b64_tr_b16 v[156:157], v19 offset:61440
    ds_read_b64_tr_b16 v[158:159], v19 offset:63488
    s_waitcnt lgkmcnt(0)
    ds_read2_b64 v[160:163], v18 offset0:0 offset1:4
    ds_read2_b64 v[164:167], v18 offset0:8 offset1:12
    ds_read2_b64 v[168:171], v18 offset0:16 offset1:20
    ds_read2_b64 v[172:175], v18 offset0:24 offset1:28
    ds_read2_b64 v[176:179], v18 offset0:32 offset1:36
    ds_read2_b64 v[180:183], v18 offset0:40 offset1:44
    ds_read2_b64 v[184:187], v18 offset0:48 offset1:52
    ds_read2_b64 v[188:191], v18 offset0:56 offset1:60
    ds_read2_b64 v[192:195], v18 offset0:64 offset1:68
    ds_read2_b64 v[196:199], v18 offset0:72 offset1:76
    ds_read2_b64 v[200:203], v18 offset0:80 offset1:84
    ds_read2_b64 v[204:207], v18 offset0:88 offset1:92
    ds_read2_b64 v[208:211], v18 offset0:96 offset1:100
    ds_read2_b64 v[212:215], v18 offset0:104 offset1:108
    ds_read2_b64 v[216:219], v18 offset0:112 offset1:116
    s_waitcnt lgkmcnt(14)
    v_mfma_f32_16x16x32_bf16 v[24:27], v[32:35], v[160:163], 0
    v_mfma_f32_16x16x32_bf16 v[28:31], v[96:99], v[160:163], 0
    ds_read2_b64 v[220:223], v18 offset0:120 offset1:124
    s_waitcnt lgkmcnt(14)
    v_mfma_f32_16x16x32_bf16 v[24:27], v[36:39], v[164:167], v[24:27]
    v_mfma_f32_16x16x32_bf16 v[28:31], v[100:103], v[164:167], v[28:31]
    s_waitcnt lgkmcnt(13)
    v_mfma_f32_16x16x32_bf16 v[24:27], v[40:43], v[168:171], v[24:27]
    v_mfma_f32_16x16x32_bf16 v[28:31], v[104:107], v[168:171], v[28:31]
    s_waitcnt lgkmcnt(12)
    v_mfma_f32_16x16x32_bf16 v[24:27], v[44:47], v[172:175], v[24:27]
    v_mfma_f32_16x16x32_bf16 v[28:31], v[108:111], v[172:175], v[28:31]
    s_waitcnt lgkmcnt(11)
    v_mfma_f32_16x16x32_bf16 v[24:27], v[48:51], v[176:179], v[24:27]
    v_mfma_f32_16x16x32_bf16 v[28:31], v[112:115], v[176:179], v[28:31]
    s_waitcnt lgkmcnt(10)
    v_mfma_f32_16x16x32_bf16 v[24:27], v[52:55], v[180:183], v[24:27]
    v_mfma_f32_16x16x32_bf16 v[28:31], v[116:119], v[180:183], v[28:31]
    s_waitcnt lgkmcnt(9)
    v_mfma_f32_16x16x32_bf16 v[24:27], v[56:59], v[184:187], v[24:27]
    v_mfma_f32_16x16x32_bf16 v[28:31], v[120:123], v[184:187], v[28:31]
    s_waitcnt lgkmcnt(8)
    v_mfma_f32_16x16x32_bf16 v[24:27], v[60:63], v[188:191], v[24:27]
    v_mfma_f32_16x16x32_bf16 v[28:31], v[124:127], v[188:191], v[28:31]
    s_waitcnt lgkmcnt(7)
    v_mfma_f32_16x16x32_bf16 v[24:27], v[64:67], v[192:195], v[24:27]
    v_mfma_f32_16x16x32_bf16 v[28:31], v[128:131], v[192:195], v[28:31]
    s_waitcnt lgkmcnt(6)
    v_mfma_f32_16x16x32_bf16 v[24:27], v[68:71], v[196:199], v[24:27]
    v_mfma_f32_16x16x32_bf16 v[28:31], v[132:135], v[196:199], v[28:31]
    s_waitcnt lgkmcnt(5)
    v_mfma_f32_16x16x32_bf16 v[24:27], v[72:75], v[200:203], v[24:27]
    v_mfma_f32_16x16x32_bf16 v[28:31], v[136:139], v[200:203], v[28:31]
    s_waitcnt lgkmcnt(4)
    v_mfma_f32_16x16x32_bf16 v[24:27], v[76:79], v[204:207], v[24:27]
    v_mfma_f32_16x16x32_bf16 v[28:31], v[140:143], v[204:207], v[28:31]
    s_waitcnt lgkmcnt(3)
    v_mfma_f32_16x16x32_bf16 v[24:27], v[80:83], v[208:211], v[24:27]
    v_mfma_f32_16x16x32_bf16 v[28:31], v[144:147], v[208:211], v[28:31]
    s_waitcnt lgkmcnt(2)
    v_mfma_f32_16x16x32_bf16 v[24:27], v[84:87], v[212:215], v[24:27]
    v_mfma_f32_16x16x32_bf16 v[28:31], v[148:151], v[212:215], v[28:31]
    s_waitcnt lgkmcnt(1)
    v_mfma_f32_16x16x32_bf16 v[24:27], v[88:91], v[216:219], v[24:27]
    v_mfma_f32_16x16x32_bf16 v[28:31], v[152:155], v[216:219], v[28:31]
    s_waitcnt lgkmcnt(0)
    v_mfma_f32_16x16x32_bf16 v[24:27], v[92:95], v[220:223], v[24:27]
    v_mfma_f32_16x16x32_bf16 v[28:31], v[156:159], v[220:223], v[28:31]
    s_nop 6
    v_cvt_pk_bf16_f32 v24, v24, v25
    v_cvt_pk_bf16_f32 v25, v26, v27
    v_cvt_pk_bf16_f32 v28, v28, v29
    v_cvt_pk_bf16_f32 v29, v30, v31
    v_min_u32 v24, -2, v24
    v_min_u32 v25, -2, v25
    v_min_u32 v28, -2, v28
    v_min_u32 v29, -2, v29
    s_mov_b32 exec_lo, 0x00030003
    s_mov_b32 exec_hi, 0x00030003
    buffer_store_dwordx2 v[24:25], v20, s[8:11], 0 offen sc1
    buffer_store_dwordx2 v[28:29], v20, s[8:11], 0 offen offset:32 sc1
    s_mov_b64 exec, -1
    s_branch L_svc_headdone
L_svq:
    s_lshl_b32 s49, s62, 10
    v_add_u32 v8, s49, v5
    global_load_dwordx4 v[20:23], v8, s[16:17]
    s_lshl_b32 s49, s62, 11
    s_add_u32 s49, s49, 524288
    v_lshlrev_b32 v14, 5, v1
    v_add_u32 v14, s49, v14
    s_mov_b32 s59, 0
    s_waitcnt vmcnt(0)
    s_cmp_eq_u32 s62, 1
    s_cbranch_scc1 L_svq_nofl
    s_lshl_b32 s49, s2, 2
    s_add_u32 s49, s49, 4096
    v_mov_b32 v6, s49
    v_mov_b32 v7, s44
    s_mov_b64 exec, 1
    buffer_store_dword v7, v6, s[8:11], 0 offen sc1
    s_mov_b64 exec, -1
L_svq_nofl:
    v_lshlrev_b32 v32, 16, v20
    v_and_b32 v33, 0xffff0000, v20
    v_lshlrev_b32 v34, 16, v21
    v_and_b32 v35, 0xffff0000, v21
    v_lshlrev_b32 v36, 16, v22
    v_and_b32 v37, 0xffff0000, v22
    v_lshlrev_b32 v38, 16, v23
    v_and_b32 v39, 0xffff0000, v23
    v_add_f32 v80, v32, v33
    v_mul_f32 v81, v32, v32
    v_add_f32 v82, v34, v35
    v_mul_f32 v83, v33, v33
    v_fmac_f32 v81, v34, v34
    v_fmac_f32 v83, v35, v35
    v_fmac_f32 v81, v36, v36
    v_fmac_f32 v83, v37, v37
    v_fmac_f32 v81, v38, v38
    v_fmac_f32 v83, v39, v39
    v_add_f32 v80, v80, v36
    v_add_f32 v82, v82, v37
    v_add_f32 v80, v80, v38
    v_add_f32 v82, v82, v39
    v_add_f32 v80, v80, v82
    v_add_f32 v81, v81, v83
    s_nop 0
    v_add_f32_dpp v80, v80, v80 row_ror:8 row_mask:0xf bank_mask:0xf
    v_add_f32_dpp v81, v81, v81 row_ror:8 row_mask:0xf bank_mask:0xf
    s_nop 0
    v_add_f32_dpp v80, v80, v80 row_ror:4 row_mask:0xf bank_mask:0xf
    v_add_f32_dpp v81, v81, v81 row_ror:4 row_mask:0xf bank_mask:0xf
    s_nop 0
    v_add_f32_dpp v80, v80, v80 row_ror:2 row_mask:0xf bank_mask:0xf
    v_add_f32_dpp v81, v81, v81 row_ror:2 row_mask:0xf bank_mask:0xf
    s_nop 0
    v_add_f32_dpp v80, v80, v80 row_ror:1 row_mask:0xf bank_mask:0xf
    v_add_f32_dpp v81, v81, v81 row_ror:1 row_mask:0xf bank_mask:0xf
    v_mov_b32 v82, v80
    v_mov_b32 v83, v81
    s_nop 0
    v_permlane16_swap_b32 v80, v82
    v_permlane16_swap_b32 v81, v83
    v_add_f32 v80, v80, v82
    v_add_f32 v81, v81, v83
    v_mov_b32 v82, v80
    v_mov_b32 v83, v81
    s_nop 0
    v_permlane32_swap_b32 v80, v82
    v_permlane32_swap_b32 v81, v83
    v_add_f32 v80, v80, v82
    v_add_f32 v81, v81, v83
    s_mov_b32 s49, 989855744
    v_mul_f32 v80, s49, v80
    v_mul_f32 v81, s49, v81
    v_fma_f32 v81, -v80, v80, v81
    v_add_f32 v81, 0x3727c5ac, v81
    v_rsq_f32 v81, v81
    v_sub_f32 v32, v32, v80
    v_sub_f32 v33, v33, v80
    v_sub_f32 v34, v34, v80
    v_sub_f32 v35, v35, v80
    v_sub_f32 v36, v36, v80
    v_sub_f32 v37, v37, v80
    v_sub_f32 v38, v38, v80
    v_sub_f32 v39, v39, v80
    v_mul_f32 v32, v32, v81
    v_mul_f32 v33, v33, v81
    v_mul_f32 v34, v34, v81
    v_mul_f32 v35, v35, v81
    v_mul_f32 v36, v36, v81
    v_mul_f32 v37, v37, v81
    v_mul_f32 v38, v38, v81
    v_mul_f32 v39, v39, v81
    s_and_b32 s57, s48, 3
    s_lshl_b32 s57, s57, 12
    s_lshr_b32 s58, s48, 2
    s_lshl_b32 s58, s58, 2
    s_add_u32 s58, s58, s4
    s_and_b32 s58, s58, 7
    s_lshl_b32 s58, s58, 8
    s_add_u32 s57, s57, s58
    s_lshl_b32 s58, s62, 11
    s_add_u32 s57, s57, s58
    s_add_u32 s57, s57, 524528
    s_add_u32 s50, s42, s57
    s_addc_u32 s51, s43, 0
    s_mov_b32 s57, 0
L_svq_sp:
    s_load_dwordx2 s[16:17], s[50:51], 0 glc
    s_add_u32 s57, s57, 1
    s_waitcnt lgkmcnt(0)
    s_cmp_ge_u32 s57, 20000
    s_cbranch_scc1 L_svq_sp_x
    s_cmp_lg_u32 s17, s44
    s_cbranch_scc1 L_svq_sp
L_svq_sp_x:
    s_mov_b32 s49, 0
    buffer_load_dwordx4 v[40:43], v14, s[8:11], s49 offen sc1
    buffer_load_dwordx4 v[44:47], v14, s[8:11], s49 offen offset:16 sc1
    s_add_u32 s49, s49, 4096
    buffer_load_dwordx4 v[48:51], v14, s[8:11], s49 offen sc1
    buffer_load_dwordx4 v[52:55], v14, s[8:11], s49 offen offset:16 sc1
    s_add_u32 s49, s49, 4096
    buffer_load_dwordx4 v[56:59], v14, s[8:11], s49 offen sc1
    buffer_load_dwordx4 v[60:63], v14, s[8:11], s49 offen offset:16 sc1
    s_add_u32 s49, s49, 4096
    buffer_load_dwordx4 v[64:67], v14, s[8:11], s49 offen sc1
    buffer_load_dwordx4 v[68:71], v14, s[8:11], s49 offen offset:16 sc1
    s_branch L_svq_chk
L_svq_poll:
    s_mov_b32 s49, 0
    buffer_load_dwordx4 v[40:43], v14, s[8:11], s49 offen sc1
    buffer_load_dwordx4 v[44:47], v14, s[8:11], s49 offen offset:16 sc1
    s_add_u32 s49, s49, 4096
    buffer_load_dwordx4 v[48:51], v14, s[8:11], s49 offen sc1
    buffer_load_dwordx4 v[52:55], v14, s[8:11], s49 offen offset:16 sc1
    s_add_u32 s49, s49, 4096
    buffer_load_dwordx4 v[56:59], v14, s[8:11], s49 offen sc1
    buffer_load_dwordx4 v[60:63], v14, s[8:11], s49 offen offset:16 sc1
    s_add_u32 s49, s49, 4096
    buffer_load_dwordx4 v[64:67], v14, s[8:11], s49 offen sc1
    buffer_load_dwordx4 v[68:71], v14, s[8:11], s49 offen offset:16 sc1
L_svq_chk:
    s_add_u32 s59, s59, 1
    s_waitcnt vmcnt(0)
    v_xor_b32 v21, s44, v41
    v_xor_b32 v22, s44, v45
    v_xor_b32 v23, s44, v49
    v_xor_b32 v24, s44, v53
    v_or3_b32 v22, v22, v23, v24
    v_xor_b32 v23, s44, v57
    v_xor_b32 v24, s44, v61
    v_or3_b32 v21, v21, v23, v24
    v_xor_b32 v23, s44, v65
    v_xor_b32 v24, s44, v69
    v_or3_b32 v22, v22, v23, v24
    v_xor_b32 v23, s44, v43
    v_xor_b32 v24, s44, v47
    v_or3_b32 v21, v21, v23, v24
    v_xor_b32 v23, s44, v51
    v_xor_b32 v24, s44, v55
    v_or3_b32 v22, v22, v23, v24
    v_xor_b32 v23, s44, v59
    v_xor_b32 v24, s44, v63
    v_or3_b32 v21, v21, v23, v24
    v_xor_b32 v23, s44, v67
    v_xor_b32 v24, s44, v71
    v_or3_b32 v22, v22, v23, v24
    v_or_b32 v21, v21, v22
    v_cmp_ne_u32 vcc, 0, v21
    s_cmp_ge_u32 s59, 20000
    s_cbranch_scc1 L_svq_x
    s_cbranch_vccz L_svq_x
    s_mov_b64 exec, vcc
    s_branch L_svq_poll
L_svq_x:
    s_mov_b64 exec, -1
    v_lshlrev_b32 v172, 16, v40
    v_and_b32 v173, 0xffff0000, v40
    v_lshlrev_b32 v174, 16, v42
    v_and_b32 v175, 0xffff0000, v42
    v_lshlrev_b32 v176, 16, v44
    v_and_b32 v177, 0xffff0000, v44
    v_lshlrev_b32 v178, 16, v46
    v_and_b32 v179, 0xffff0000, v46
    v_lshlrev_b32 v188, 16, v56
    v_and_b32 v189, 0xffff0000, v56
    v_lshlrev_b32 v190, 16, v58
    v_and_b32 v191, 0xffff0000, v58
    v_lshlrev_b32 v192, 16, v60
    v_and_b32 v193, 0xffff0000, v60
    v_lshlrev_b32 v194, 16, v62
    v_and_b32 v195, 0xffff0000, v62
    v_add_f32 v172, v172, v188
    v_add_f32 v173, v173, v189
    v_add_f32 v174, v174, v190
    v_add_f32 v175, v175, v191
    v_add_f32 v176, v176, v192
    v_add_f32 v177, v177, v193
    v_add_f32 v178, v178, v194
    v_add_f32 v179, v179, v195
    v_lshlrev_b32 v180, 16, v48
    v_and_b32 v181, 0xffff0000, v48
    v_lshlrev_b32 v182, 16, v50
    v_and_b32 v183, 0xffff0000, v50
    v_lshlrev_b32 v184, 16, v52
    v_and_b32 v185, 0xffff0000, v52
    v_lshlrev_b32 v186, 16, v54
    v_and_b32 v187, 0xffff0000, v54
    v_lshlrev_b32 v188, 16, v64
    v_and_b32 v189, 0xffff0000, v64
    v_lshlrev_b32 v190, 16, v66
    v_and_b32 v191, 0xffff0000, v66
    v_lshlrev_b32 v192, 16, v68
    v_and_b32 v193, 0xffff0000, v68
    v_lshlrev_b32 v194, 16, v70
    v_and_b32 v195, 0xffff0000, v70
    v_add_f32 v180, v180, v188
    v_add_f32 v181, v181, v189
    v_add_f32 v182, v182, v190
    v_add_f32 v183, v183, v191
    v_add_f32 v184, v184, v192
    v_add_f32 v185, v185, v193
    v_add_f32 v186, v186, v194
    v_add_f32 v187, v187, v195
    v_add_f32 v180, 1.0, v180
    v_add_f32 v181, 1.0, v181
    v_add_f32 v182, 1.0, v182
    v_add_f32 v183, 1.0, v183
    v_add_f32 v184, 1.0, v184
    v_add_f32 v185, 1.0, v185
    v_add_f32 v186, 1.0, v186
    v_add_f32 v187, 1.0, v187
    v_fma_f32 v172, v32, v180, v172
    v_fma_f32 v173, v33, v181, v173
    v_fma_f32 v174, v34, v182, v174
    v_fma_f32 v175, v35, v183, v175
    v_fma_f32 v176, v36, v184, v176
    v_fma_f32 v177, v37, v185, v177
    v_fma_f32 v178, v38, v186, v178
    v_fma_f32 v179, v39, v187, v179
    v_cvt_pk_bf16_f32 v24, v172, v173
    v_cvt_pk_bf16_f32 v25, v174, v175
    v_cvt_pk_bf16_f32 v26, v176, v177
    v_cvt_pk_bf16_f32 v27, v178, v179
    s_mul_i32 s49, s62, 1040
    s_add_u32 s49, s49, 131072
    v_add_u32 v8, s49, v5
    ds_write_b128 v8, v[24:27]
    s_waitcnt lgkmcnt(0)
    s_barrier
    s_cmp_eq_u32 s62, 1
    s_cbranch_scc1 L_svc_t2
    s_branch L_svc_q
L_svc_headdone:
    s_cmp_eq_u32 s62, 1
    s_cbranch_scc0 L_svc_q
    s_branch L_svc_end
L_svc_nonp:

L_svc_q:
    s_lshl_b32 s49, s56, 11
    s_add_u32 s49, s49, 16384
    v_add_u32 v6, s49, v5
    v_add_u32 v7, 4096, v5
    s_mov_b32 s47, 0

    s_lshl_b32 s49, s56, 11
    s_add_u32 s49, s49, 16384
    s_add_u32 s50, s42, s49
    s_addc_u32 s51, s43, 0
    s_mov_b32 s57, 0
L_sq_poll:
    s_load_dwordx2 s[16:17], s[50:51], 240 glc
    s_load_dwordx2 s[18:19], s[50:51], 496 glc
    s_load_dwordx2 s[20:21], s[50:51], 752 glc
    s_load_dwordx2 s[22:23], s[50:51], 1008 glc
    s_load_dwordx2 s[24:25], s[50:51], 1264 glc
    s_load_dwordx2 s[26:27], s[50:51], 1520 glc
    s_load_dwordx2 s[28:29], s[50:51], 1776 glc
    s_load_dwordx2 s[30:31], s[50:51], 2032 glc
    s_add_u32 s57, s57, 1
    s_waitcnt lgkmcnt(0)
    s_mov_b32 s58, 0
    s_cmp_eq_u32 s17, s44
    s_addc_u32 s58, s58, 0
    s_cmp_eq_u32 s19, s44
    s_addc_u32 s58, s58, 0
    s_cmp_eq_u32 s21, s44
    s_addc_u32 s58, s58, 0
    s_cmp_eq_u32 s23, s44
    s_addc_u32 s58, s58, 0
    s_cmp_eq_u32 s25, s44
    s_addc_u32 s58, s58, 0
    s_cmp_eq_u32 s27, s44
    s_addc_u32 s58, s58, 0
    s_cmp_eq_u32 s29, s44
    s_addc_u32 s58, s58, 0
    s_cmp_eq_u32 s31, s44
    s_addc_u32 s58, s58, 0
    s_cmp_ge_u32 s57, 20000
    s_cbranch_scc1 L_sq_x
    s_cmp_lt_u32 s58, 8
    s_cbranch_scc1 L_sq_poll
L_sq_x:
L_q_poll:
    buffer_load_dwordx4 v[16:19], v6, s[8:11], 0 offen sc1
    buffer_load_dwordx4 v[20:23], v6, s[8:11], 0 offen offset:1024 sc1
    buffer_load_dwordx4 v[24:27], v7, s[8:11], 0 offen sc1
    s_add_u32 s47, s47, 1
    s_waitcnt vmcnt(0)
    v_xor_b32 v8, s44, v17
    v_xor_b32 v9, s44, v19
    v_xor_b32 v10, s44, v21
    v_xor_b32 v11, s44, v23
    v_or3_b32 v8, v8, v9, v10
    v_or_b32 v8, v8, v11
    v_xor_b32 v9, s44, v24
    v_xor_b32 v10, s44, v25
    v_xor_b32 v11, s44, v26
    v_or3_b32 v8, v8, v9, v10
    v_xor_b32 v9, s44, v27
    v_or3_b32 v8, v8, v11, v9
    v_cmp_ne_u32 vcc, 0, v8
    s_cmp_ge_u32 s47, 20000
    s_cbranch_scc1 L_q_poll_x
    s_cbranch_vccz L_q_poll_x
    s_mov_b64 exec, vcc
    s_branch L_q_poll
L_q_poll_x:
    s_mov_b64 exec, -1
    v_lshlrev_b32 v8, 3, v1
    v_lshrrev_b32 v9, 5, v1
    v_lshl_add_u32 v8, v9, 5, v8
    v_add_u32 v8, 133184, v8
    ds_write2_b32 v8, v16, v18 offset0:0 offset1:1
    ds_write2_b32 v8, v20, v22 offset0:144 offset1:145
    v_mov_b32 v10, 142656
    v_mov_b32 v11, 1
    s_mov_b64 exec, 1
    ds_write_b32 v10, v11
    s_mov_b64 exec, -1
    s_branch L_svc_end
L_svc_tail:
    s_barrier
    s_cmp_lt_u32 s5, 20
    s_cbranch_scc0 L_svc_t2m
    v_mov_b32 v194, 142704
    s_mov_b32 s46, 1
    s_mov_b32 s47, 0
L_w5_t1:
    ds_read_b128 v[190:193], v194
    s_add_u32 s47, s47, 1
    s_waitcnt lgkmcnt(0)
    v_xor_b32 v190, s46, v190
    v_xor_b32 v191, s46, v191
    v_xor_b32 v192, s46, v192
    v_xor_b32 v193, s46, v193
    v_or3_b32 v190, v190, v191, v192
    v_or_b32 v190, v190, v193
    v_cmp_ne_u32 vcc, 0, v190
    s_cmp_ge_u32 s47, 320000
    s_cbranch_scc1 L_w5_t1_x
    s_cbranch_vccnz L_w5_t1
L_w5_t1_x:
    s_setprio 0
    s_branch L_ctrl_t1
L_svc_t2m:
    v_mov_b32 v194, 142704
    s_mov_b32 s46, 1
    s_mov_b32 s47, 0
L_w5_t2:
    ds_read_b128 v[190:193], v194
    s_add_u32 s47, s47, 1
    s_waitcnt lgkmcnt(0)
    v_xor_b32 v190, s46, v190
    v_xor_b32 v191, s46, v191
    v_xor_b32 v192, s46, v192
    v_xor_b32 v193, s46, v193
    v_or3_b32 v190, v190, v191, v192
    v_or_b32 v190, v190, v193
    v_cmp_ne_u32 vcc, 0, v190
    s_cmp_ge_u32 s47, 320000
    s_cbranch_scc1 L_w5_t2_x
    s_cbranch_vccnz L_w5_t2
L_w5_t2_x:
L_svc_t2:
    v_mov_b32 v194, 142720
    s_mov_b32 s46, 1
    s_mov_b32 s47, 0
L_t2_fp:
    ds_read_b128 v[190:193], v194
    s_add_u32 s47, s47, 1
    s_waitcnt lgkmcnt(0)
    v_xor_b32 v190, s46, v190
    v_xor_b32 v191, s46, v191
    v_xor_b32 v192, s46, v192
    v_xor_b32 v193, s46, v193
    v_or3_b32 v190, v190, v191, v192
    v_or_b32 v190, v190, v193
    v_cmp_ne_u32 vcc, 0, v190
    s_cmp_ge_u32 s47, 320000
    s_cbranch_scc1 L_t2_fp_x
    s_cbranch_vccnz L_t2_fp
L_t2_fp_x:
    s_setprio 0
    s_sub_u32 s49, s5, 4
    s_cmp_lt_u32 s49, 7
    s_cbranch_scc0 L_svc_end
    s_mul_i32 s49, s4, 7
    s_add_u32 s49, s49, s5
    s_sub_u32 s49, s49, 4
    v_lshrrev_b32 v8, 2, v1
    v_and_b32 v9, 3, v1
    v_lshrrev_b32 v10, 3, v1
    v_and_b32 v10, 2, v10
    v_xor_b32 v9, v9, v10
    v_lshlrev_b32 v9, 4, v9
    v_mul_u32_u24 v8, 3584, v8
    v_add_u32 v8, v8, v9
    s_lshl_b32 s50, s49, 6
    v_add_u32 v8, s50, v8
    s_mov_b32 s12, s28
    s_mov_b32 s13, s29
    s_mov_b32 s14, 1835008
    s_mov_b32 s15, 0x20000
    s_mov_b32 s50, 0
    s_mov_b32 s51, 0
    s_mov_b32 s52, 4
L_dma_1:
    s_mov_b32 m0, s51
    s_add_u32 s51, s51, 1024
    buffer_load_dwordx4 v8, s[12:15], s50 offen nt lds
    s_add_u32 s50, s50, 57344
    s_mov_b32 m0, s51
    s_add_u32 s51, s51, 1024
    buffer_load_dwordx4 v8, s[12:15], s50 offen nt lds
    s_add_u32 s50, s50, 57344
    s_mov_b32 m0, s51
    s_add_u32 s51, s51, 1024
    buffer_load_dwordx4 v8, s[12:15], s50 offen nt lds
    s_add_u32 s50, s50, 57344
    s_mov_b32 m0, s51
    s_add_u32 s51, s51, 1024
    buffer_load_dwordx4 v8, s[12:15], s50 offen nt lds
    s_add_u32 s50, s50, 57344
    s_mov_b32 m0, s51
    s_add_u32 s51, s51, 1024
    buffer_load_dwordx4 v8, s[12:15], s50 offen nt lds
    s_add_u32 s50, s50, 57344
    s_mov_b32 m0, s51
    s_add_u32 s51, s51, 1024
    buffer_load_dwordx4 v8, s[12:15], s50 offen nt lds
    s_add_u32 s50, s50, 57344
    s_mov_b32 m0, s51
    s_add_u32 s51, s51, 1024
    buffer_load_dwordx4 v8, s[12:15], s50 offen nt lds
    s_add_u32 s50, s50, 57344
    s_mov_b32 m0, s51
    s_add_u32 s51, s51, 1024
    buffer_load_dwordx4 v8, s[12:15], s50 offen nt lds
    s_add_u32 s50, s50, 57344
    s_sub_u32 s52, s52, 1
    s_cmp_lg_u32 s52, 0
    s_cbranch_scc1 L_dma_1
    s_mov_b32 s12, s30
    s_mov_b32 s13, s31
    s_mov_b32 s14, 1835008
    s_mov_b32 s15, 0x20000
    s_mov_b32 s50, 0
    s_mov_b32 s51, 32768
    s_mov_b32 s52, 4
L_dma_2:
    s_mov_b32 m0, s51
    s_add_u32 s51, s51, 1024
    buffer_load_dwordx4 v8, s[12:15], s50 offen nt lds
    s_add_u32 s50, s50, 57344
    s_mov_b32 m0, s51
    s_add_u32 s51, s51, 1024
    buffer_load_dwordx4 v8, s[12:15], s50 offen nt lds
    s_add_u32 s50, s50, 57344
    s_mov_b32 m0, s51
    s_add_u32 s51, s51, 1024
    buffer_load_dwordx4 v8, s[12:15], s50 offen nt lds
    s_add_u32 s50, s50, 57344
    s_mov_b32 m0, s51
    s_add_u32 s51, s51, 1024
    buffer_load_dwordx4 v8, s[12:15], s50 offen nt lds
    s_add_u32 s50, s50, 57344
    s_mov_b32 m0, s51
    s_add_u32 s51, s51, 1024
    buffer_load_dwordx4 v8, s[12:15], s50 offen nt lds
    s_add_u32 s50, s50, 57344
    s_mov_b32 m0, s51
    s_add_u32 s51, s51, 1024
    buffer_load_dwordx4 v8, s[12:15], s50 offen nt lds
    s_add_u32 s50, s50, 57344
    s_mov_b32 m0, s51
    s_add_u32 s51, s51, 1024
    buffer_load_dwordx4 v8, s[12:15], s50 offen nt lds
    s_add_u32 s50, s50, 57344
    s_mov_b32 m0, s51
    s_add_u32 s51, s51, 1024
    buffer_load_dwordx4 v8, s[12:15], s50 offen nt lds
    s_add_u32 s50, s50, 57344
    s_sub_u32 s52, s52, 1
    s_cmp_lg_u32 s52, 0
    s_cbranch_scc1 L_dma_2
    s_mov_b32 s12, s32
    s_mov_b32 s13, s33
    s_mov_b32 s14, 1835008
    s_mov_b32 s15, 0x20000
    s_lshl_b32 s50, s49, 15
    s_mov_b32 s51, 65536
    s_mov_b32 s52, 4
    v_xor_b32 v16, 0, v5
    v_xor_b32 v17, 32, v5
    v_xor_b32 v18, 64, v5
    v_xor_b32 v19, 96, v5
    v_xor_b32 v20, 128, v5
    v_xor_b32 v21, 160, v5
    v_xor_b32 v22, 192, v5
    v_xor_b32 v23, 224, v5
L_dmad_3:
    s_mov_b32 m0, s51
    s_add_u32 s51, s51, 1024
    buffer_load_dwordx4 v16, s[12:15], s50 offen nt lds
    s_add_u32 s50, s50, 1024
    s_mov_b32 m0, s51
    s_add_u32 s51, s51, 1024
    buffer_load_dwordx4 v17, s[12:15], s50 offen nt lds
    s_add_u32 s50, s50, 1024
    s_mov_b32 m0, s51
    s_add_u32 s51, s51, 1024
    buffer_load_dwordx4 v18, s[12:15], s50 offen nt lds
    s_add_u32 s50, s50, 1024
    s_mov_b32 m0, s51
    s_add_u32 s51, s51, 1024
    buffer_load_dwordx4 v19, s[12:15], s50 offen nt lds
    s_add_u32 s50, s50, 1024
    s_mov_b32 m0, s51
    s_add_u32 s51, s51, 1024
    buffer_load_dwordx4 v20, s[12:15], s50 offen nt lds
    s_add_u32 s50, s50, 1024
    s_mov_b32 m0, s51
    s_add_u32 s51, s51, 1024
    buffer_load_dwordx4 v21, s[12:15], s50 offen nt lds
    s_add_u32 s50, s50, 1024
    s_mov_b32 m0, s51
    s_add_u32 s51, s51, 1024
    buffer_load_dwordx4 v22, s[12:15], s50 offen nt lds
    s_add_u32 s50, s50, 1024
    s_mov_b32 m0, s51
    s_add_u32 s51, s51, 1024
    buffer_load_dwordx4 v23, s[12:15], s50 offen nt lds
    s_add_u32 s50, s50, 1024
    s_sub_u32 s52, s52, 1
    s_cmp_lg_u32 s52, 0
    s_cbranch_scc1 L_dmad_3
    s_branch L_ctrl_w
L_ctrl_t1:
    s_sub_u32 s49, s5, 12
    s_lshr_b32 s50, s49, 2
    s_and_b32 s49, s49, 3
    s_lshl_b32 s51, s4, 1
    s_add_u32 s50, s50, s51
    s_lshl_b32 s50, s50, 18
    s_lshl_b32 s49, s49, 8
    s_add_u32 s50, s50, s49
    v_lshlrev_b32 v8, 1, v3
    v_xor_b32 v9, v8, v2
    v_xor_b32 v10, 8, v9
    v_lshlrev_b32 v9, 4, v9
    v_lshlrev_b32 v10, 4, v10
    v_lshl_add_u32 v9, v3, 10, v9
    v_lshl_add_u32 v10, v3, 10, v10
    s_mov_b32 s12, s24
    s_mov_b32 s13, s25
    s_mov_b32 s14, 4194304
    s_mov_b32 s15, 0x20000
    s_mov_b32 s51, 0
    s_mov_b32 s52, 32
L_dma_wo:
    s_mov_b32 m0, s51
    s_add_u32 s51, s51, 1024
    buffer_load_dwordx4 v9, s[12:15], s50 offen nt lds
    s_add_u32 s50, s50, 4096
    s_mov_b32 m0, s51
    s_add_u32 s51, s51, 1024
    buffer_load_dwordx4 v10, s[12:15], s50 offen nt lds
    s_add_u32 s50, s50, 4096
    s_sub_u32 s52, s52, 1
    s_cmp_lg_u32 s52, 0
    s_cbranch_scc1 L_dma_wo
L_ctrl_w:
    s_cmp_lt_u32 s5, 12
    s_cbranch_scc0 L_w5_one
    s_waitcnt vmcnt(32)
    v_mov_b32 v10, 142664
    v_mov_b32 v11, 1
    s_mov_b64 exec, 1
    ds_write_b32 v10, v11
    s_mov_b64 exec, -1
L_w5_one:
    s_waitcnt vmcnt(0)
    v_mov_b32 v10, 142660
    v_mov_b32 v11, 1
    s_mov_b64 exec, 1
    ds_write_b32 v10, v11
    s_mov_b64 exec, -1
    s_waitcnt lgkmcnt(0)
L_svc_end:
    s_endpgm
L_att2:
    s_mov_b32 s8, s42
    s_mov_b32 s9, s43
    s_mov_b32 s10, 2097152
    s_mov_b32 s11, 0x20000
    v_lshrrev_b32 v8, 2, v2
    v_mul_u32_u24 v9, 288, v8
    v_lshl_add_u32 v9, v3, 4, v9
    v_add_u32 v9, 133184, v9
    v_lshlrev_b32 v10, 4, v8
    v_add_u32 v10, 142528, v10
    v_and_b32 v11, 1, v2
    v_lshlrev_b32 v11, 4, v11
    v_mov_b32 v12, 0xffff
    v_lshlrev_b32 v12, v11, v12
    v_and_b32 v11, 2, v2
    v_cmp_eq_u32 vcc, 0, v11
    s_nop 1
    v_cndmask_b32 v224, 0, v12, vcc
    v_xor_b32 v225, v224, v12
    s_lshl_b32 s45, s3, 2
    v_add_u32 v226, s45, v10
    s_add_u32 s57, s45, 142672
    s_add_u32 s58, s45, 142688
    v_mov_b32 v232, 142656
    s_mov_b32 s46, 1
    s_mov_b32 s47, 0
L_att2_wq:
    ds_read_b32 v228, v232
    s_add_u32 s47, s47, 1
    s_waitcnt lgkmcnt(0)
    v_cmp_ne_u32 vcc, s46, v228
    s_cmp_ge_u32 s47, 320000
    s_cbranch_scc1 L_att2_wq_x
    s_cbranch_vccnz L_att2_wq
L_att2_wq_x:
    s_setprio 2
    ds_read_b128 v[176:179], v9 offset:0
    ds_read_b128 v[180:183], v9 offset:64
    ds_read_b128 v[184:187], v9 offset:128
    ds_read_b128 v[188:191], v9 offset:192
    s_waitcnt lgkmcnt(0)
    s_waitcnt vmcnt(12)
    v_mfma_f32_16x16x32_bf16 v[196:199], v[16:19], v[176:179], 0
    v_mfma_f32_16x16x32_bf16 v[196:199], v[20:23], v[180:183], v[196:199]
    v_mfma_f32_16x16x32_bf16 v[196:199], v[24:27], v[184:187], v[196:199]
    v_mfma_f32_16x16x32_bf16 v[196:199], v[28:31], v[188:191], v[196:199]
    s_waitcnt vmcnt(8)
    v_mfma_f32_16x16x32_bf16 v[200:203], v[32:35], v[176:179], 0
    v_mfma_f32_16x16x32_bf16 v[200:203], v[36:39], v[180:183], v[200:203]
    v_mfma_f32_16x16x32_bf16 v[200:203], v[40:43], v[184:187], v[200:203]
    v_mfma_f32_16x16x32_bf16 v[200:203], v[44:47], v[188:191], v[200:203]
    s_nop 2
    v_max3_f32 v8, v196, v197, v198
    s_nop 3
    v_max3_f32 v11, v199, v200, v201
    v_max3_f32 v8, v8, v202, v203
    v_max_f32 v8, v8, v11
    v_mov_b32 v11, v8
    s_nop 1
    v_permlane16_swap_b32 v8, v11
    v_max_f32 v8, v8, v11
    v_mov_b32 v11, v8
    s_nop 1
    v_permlane32_swap_b32 v8, v11
    v_max_f32 v8, v8, v11
    s_mov_b64 exec, 0x1111
    ds_write_b32 v226, v8
    s_mov_b64 exec, -1
    s_mov_b32 s45, 1040356334
    v_mul_f32 v8, s45, v8
    v_sub_f32 v8, 0, v8
    v_mov_b64 v[176:177], 0
    v_mov_b64 v[180:181], 0
    v_mov_b64 v[184:185], 0
    v_mov_b64 v[188:189], 0
    v_mov_b64 v[192:193], 0
    v_fma_f32 v196, v196, s45, v8
    v_exp_f32 v196, v196
    v_fma_f32 v197, v197, s45, v8
    v_exp_f32 v197, v197
    v_fma_f32 v198, v198, s45, v8
    v_exp_f32 v198, v198
    v_cvt_pk_bf16_f32 v13, v196, v196
    v_and_b32 v178, v13, v224
    v_and_b32 v179, v13, v225
    s_waitcnt vmcnt(4)
    v_cvt_pk_bf16_f32 v13, v197, v197
    v_and_b32 v182, v13, v224
    v_and_b32 v183, v13, v225
    v_mfma_f32_16x16x32_bf16 v[216:219], v[178:181], v[96:99], 0
    v_fma_f32 v199, v199, s45, v8
    v_exp_f32 v199, v199
    v_mfma_f32_16x16x32_bf16 v[220:223], v[176:179], v[96:99], 0
    v_add_f32 v11, v196, v197
    v_cvt_pk_bf16_f32 v13, v198, v198
    v_and_b32 v186, v13, v224
    v_and_b32 v187, v13, v225
    v_mfma_f32_16x16x32_bf16 v[216:219], v[182:185], v[100:103], v[216:219]
    v_fma_f32 v200, v200, s45, v8
    v_exp_f32 v200, v200
    v_mfma_f32_16x16x32_bf16 v[220:223], v[180:183], v[100:103], v[220:223]
    v_add_f32 v11, v11, v198
    v_cvt_pk_bf16_f32 v13, v199, v199
    v_and_b32 v190, v13, v224
    v_and_b32 v191, v13, v225
    v_mfma_f32_16x16x32_bf16 v[216:219], v[186:189], v[104:107], v[216:219]
    v_fma_f32 v201, v201, s45, v8
    v_exp_f32 v201, v201
    v_mfma_f32_16x16x32_bf16 v[220:223], v[184:187], v[104:107], v[220:223]
    v_add_f32 v11, v11, v199
    v_cvt_pk_bf16_f32 v13, v200, v200
    v_and_b32 v178, v13, v224
    v_and_b32 v179, v13, v225
    v_mfma_f32_16x16x32_bf16 v[216:219], v[190:193], v[108:111], v[216:219]
    v_fma_f32 v202, v202, s45, v8
    v_exp_f32 v202, v202
    v_mfma_f32_16x16x32_bf16 v[220:223], v[188:191], v[108:111], v[220:223]
    v_add_f32 v11, v11, v200
    s_waitcnt vmcnt(0)
    v_cvt_pk_bf16_f32 v13, v201, v201
    v_and_b32 v182, v13, v224
    v_and_b32 v183, v13, v225
    v_mfma_f32_16x16x32_bf16 v[216:219], v[178:181], v[112:115], v[216:219]
    v_fma_f32 v203, v203, s45, v8
    v_exp_f32 v203, v203
    v_mfma_f32_16x16x32_bf16 v[220:223], v[176:179], v[112:115], v[220:223]
    v_add_f32 v11, v11, v201
    v_cvt_pk_bf16_f32 v13, v202, v202
    v_and_b32 v186, v13, v224
    v_and_b32 v187, v13, v225
    v_mfma_f32_16x16x32_bf16 v[216:219], v[182:185], v[116:119], v[216:219]
    v_mfma_f32_16x16x32_bf16 v[220:223], v[180:183], v[116:119], v[220:223]
    v_add_f32 v11, v11, v202
    v_cvt_pk_bf16_f32 v13, v203, v203
    v_and_b32 v190, v13, v224
    v_and_b32 v191, v13, v225
    v_mfma_f32_16x16x32_bf16 v[216:219], v[186:189], v[120:123], v[216:219]
    v_mfma_f32_16x16x32_bf16 v[220:223], v[184:187], v[120:123], v[220:223]
    v_add_f32 v11, v11, v203
    v_mfma_f32_16x16x32_bf16 v[216:219], v[190:193], v[124:127], v[216:219]
    v_mfma_f32_16x16x32_bf16 v[220:223], v[188:191], v[124:127], v[220:223]
    v_mov_b32 v12, v11
    s_nop 1
    v_permlane16_swap_b32 v11, v12
    v_add_f32 v11, v11, v12
    v_mov_b32 v12, v11
    s_nop 1
    v_permlane32_swap_b32 v11, v12
    v_add_f32 v11, v11, v12
    s_mov_b64 exec, 0x1111
    ds_write_b32 v226, v11 offset:64
    s_mov_b64 exec, -1
    s_branch L_att_fin
L_att4:
    s_mov_b32 s8, s42
    s_mov_b32 s9, s43
    s_mov_b32 s10, 2097152
    s_mov_b32 s11, 0x20000
    v_lshrrev_b32 v8, 2, v2
    v_mul_u32_u24 v9, 288, v8
    v_lshl_add_u32 v9, v3, 4, v9
    v_add_u32 v9, 133184, v9
    v_lshlrev_b32 v10, 4, v8
    v_add_u32 v10, 142528, v10
    v_and_b32 v11, 1, v2
    v_lshlrev_b32 v11, 4, v11
    v_mov_b32 v12, 0xffff
    v_lshlrev_b32 v12, v11, v12
    v_and_b32 v11, 2, v2
    v_cmp_eq_u32 vcc, 0, v11
    s_nop 1
    v_cndmask_b32 v224, 0, v12, vcc
    v_xor_b32 v225, v224, v12
    s_lshl_b32 s45, s3, 2
    v_add_u32 v226, s45, v10
    s_add_u32 s57, s45, 142672
    s_add_u32 s58, s45, 142688
    v_mov_b32 v232, 142656
    s_mov_b32 s46, 1
    s_mov_b32 s47, 0
L_att4_wq:
    ds_read_b32 v228, v232
    s_add_u32 s47, s47, 1
    s_waitcnt lgkmcnt(0)
    v_cmp_ne_u32 vcc, s46, v228
    s_cmp_ge_u32 s47, 320000
    s_cbranch_scc1 L_att4_wq_x
    s_cbranch_vccnz L_att4_wq
L_att4_wq_x:
    s_setprio 2
    ds_read_b128 v[176:179], v9 offset:0
    ds_read_b128 v[180:183], v9 offset:64
    ds_read_b128 v[184:187], v9 offset:128
    ds_read_b128 v[188:191], v9 offset:192
    s_waitcnt lgkmcnt(0)
    s_waitcnt vmcnt(28)
    v_mfma_f32_16x16x32_bf16 v[196:199], v[16:19], v[176:179], 0
    v_mfma_f32_16x16x32_bf16 v[196:199], v[20:23], v[180:183], v[196:199]
    v_mfma_f32_16x16x32_bf16 v[196:199], v[24:27], v[184:187], v[196:199]
    v_mfma_f32_16x16x32_bf16 v[196:199], v[28:31], v[188:191], v[196:199]
    s_waitcnt vmcnt(24)
    v_mfma_f32_16x16x32_bf16 v[200:203], v[32:35], v[176:179], 0
    v_mfma_f32_16x16x32_bf16 v[200:203], v[36:39], v[180:183], v[200:203]
    v_mfma_f32_16x16x32_bf16 v[200:203], v[40:43], v[184:187], v[200:203]
    v_mfma_f32_16x16x32_bf16 v[200:203], v[44:47], v[188:191], v[200:203]
    s_waitcnt vmcnt(20)
    v_mfma_f32_16x16x32_bf16 v[204:207], v[48:51], v[176:179], 0
    v_mfma_f32_16x16x32_bf16 v[204:207], v[52:55], v[180:183], v[204:207]
    v_mfma_f32_16x16x32_bf16 v[204:207], v[56:59], v[184:187], v[204:207]
    v_mfma_f32_16x16x32_bf16 v[204:207], v[60:63], v[188:191], v[204:207]
    s_waitcnt vmcnt(16)
    v_mfma_f32_16x16x32_bf16 v[208:211], v[64:67], v[176:179], 0
    v_mfma_f32_16x16x32_bf16 v[208:211], v[68:71], v[180:183], v[208:211]
    v_mfma_f32_16x16x32_bf16 v[208:211], v[72:75], v[184:187], v[208:211]
    v_mfma_f32_16x16x32_bf16 v[208:211], v[76:79], v[188:191], v[208:211]
    v_max3_f32 v8, v196, v197, v198
    v_max3_f32 v11, v199, v200, v201
    v_max3_f32 v8, v8, v202, v203
    v_max3_f32 v11, v11, v204, v205
    v_max3_f32 v8, v8, v206, v207
    s_nop 2
    v_max3_f32 v11, v11, v208, v209
    v_max3_f32 v8, v8, v210, v211
    v_max_f32 v8, v8, v11
    v_mov_b32 v11, v8
    s_nop 1
    v_permlane16_swap_b32 v8, v11
    v_max_f32 v8, v8, v11
    v_mov_b32 v11, v8
    s_nop 1
    v_permlane32_swap_b32 v8, v11
    v_max_f32 v8, v8, v11
    s_mov_b64 exec, 0x1111
    ds_write_b32 v226, v8
    s_mov_b64 exec, -1
    s_mov_b32 s45, 1040356334
    v_mul_f32 v8, s45, v8
    v_sub_f32 v8, 0, v8
    v_mov_b64 v[176:177], 0
    v_mov_b64 v[180:181], 0
    v_mov_b64 v[184:185], 0
    v_mov_b64 v[188:189], 0
    v_mov_b64 v[192:193], 0
    v_fma_f32 v196, v196, s45, v8
    v_exp_f32 v196, v196
    v_fma_f32 v197, v197, s45, v8
    v_exp_f32 v197, v197
    v_fma_f32 v198, v198, s45, v8
    v_exp_f32 v198, v198
    v_cvt_pk_bf16_f32 v13, v196, v196
    v_and_b32 v178, v13, v224
    v_and_b32 v179, v13, v225
    s_waitcnt vmcnt(12)
    v_cvt_pk_bf16_f32 v13, v197, v197
    v_and_b32 v182, v13, v224
    v_and_b32 v183, v13, v225
    v_mfma_f32_16x16x32_bf16 v[216:219], v[178:181], v[96:99], 0
    v_fma_f32 v199, v199, s45, v8
    v_exp_f32 v199, v199
    v_mfma_f32_16x16x32_bf16 v[220:223], v[176:179], v[96:99], 0
    v_add_f32 v11, v196, v197
    v_cvt_pk_bf16_f32 v13, v198, v198
    v_and_b32 v186, v13, v224
    v_and_b32 v187, v13, v225
    v_mfma_f32_16x16x32_bf16 v[216:219], v[182:185], v[100:103], v[216:219]
    v_fma_f32 v200, v200, s45, v8
    v_exp_f32 v200, v200
    v_mfma_f32_16x16x32_bf16 v[220:223], v[180:183], v[100:103], v[220:223]
    v_add_f32 v11, v11, v198
    v_cvt_pk_bf16_f32 v13, v199, v199
    v_and_b32 v190, v13, v224
    v_and_b32 v191, v13, v225
    v_mfma_f32_16x16x32_bf16 v[216:219], v[186:189], v[104:107], v[216:219]
    v_fma_f32 v201, v201, s45, v8
    v_exp_f32 v201, v201
    v_mfma_f32_16x16x32_bf16 v[220:223], v[184:187], v[104:107], v[220:223]
    v_add_f32 v11, v11, v199
    v_cvt_pk_bf16_f32 v13, v200, v200
    v_and_b32 v178, v13, v224
    v_and_b32 v179, v13, v225
    v_mfma_f32_16x16x32_bf16 v[216:219], v[190:193], v[108:111], v[216:219]
    v_fma_f32 v202, v202, s45, v8
    v_exp_f32 v202, v202
    v_mfma_f32_16x16x32_bf16 v[220:223], v[188:191], v[108:111], v[220:223]
    v_add_f32 v11, v11, v200
    s_waitcnt vmcnt(8)
    v_cvt_pk_bf16_f32 v13, v201, v201
    v_and_b32 v182, v13, v224
    v_and_b32 v183, v13, v225
    v_mfma_f32_16x16x32_bf16 v[216:219], v[178:181], v[112:115], v[216:219]
    v_fma_f32 v203, v203, s45, v8
    v_exp_f32 v203, v203
    v_mfma_f32_16x16x32_bf16 v[220:223], v[176:179], v[112:115], v[220:223]
    v_add_f32 v11, v11, v201
    v_cvt_pk_bf16_f32 v13, v202, v202
    v_and_b32 v186, v13, v224
    v_and_b32 v187, v13, v225
    v_mfma_f32_16x16x32_bf16 v[216:219], v[182:185], v[116:119], v[216:219]
    v_fma_f32 v204, v204, s45, v8
    v_exp_f32 v204, v204
    v_mfma_f32_16x16x32_bf16 v[220:223], v[180:183], v[116:119], v[220:223]
    v_add_f32 v11, v11, v202
    v_cvt_pk_bf16_f32 v13, v203, v203
    v_and_b32 v190, v13, v224
    v_and_b32 v191, v13, v225
    v_mfma_f32_16x16x32_bf16 v[216:219], v[186:189], v[120:123], v[216:219]
    v_fma_f32 v205, v205, s45, v8
    v_exp_f32 v205, v205
    v_mfma_f32_16x16x32_bf16 v[220:223], v[184:187], v[120:123], v[220:223]
    v_add_f32 v11, v11, v203
    v_cvt_pk_bf16_f32 v13, v204, v204
    v_and_b32 v178, v13, v224
    v_and_b32 v179, v13, v225
    v_mfma_f32_16x16x32_bf16 v[216:219], v[190:193], v[124:127], v[216:219]
    v_fma_f32 v206, v206, s45, v8
    v_exp_f32 v206, v206
    v_mfma_f32_16x16x32_bf16 v[220:223], v[188:191], v[124:127], v[220:223]
    v_add_f32 v11, v11, v204
    s_waitcnt vmcnt(4)
    v_cvt_pk_bf16_f32 v13, v205, v205
    v_and_b32 v182, v13, v224
    v_and_b32 v183, v13, v225
    v_mfma_f32_16x16x32_bf16 v[216:219], v[178:181], v[128:131], v[216:219]
    v_fma_f32 v207, v207, s45, v8
    v_exp_f32 v207, v207
    v_mfma_f32_16x16x32_bf16 v[220:223], v[176:179], v[128:131], v[220:223]
    v_add_f32 v11, v11, v205
    v_cvt_pk_bf16_f32 v13, v206, v206
    v_and_b32 v186, v13, v224
    v_and_b32 v187, v13, v225
    v_mfma_f32_16x16x32_bf16 v[216:219], v[182:185], v[132:135], v[216:219]
    v_fma_f32 v208, v208, s45, v8
    v_exp_f32 v208, v208
    v_mfma_f32_16x16x32_bf16 v[220:223], v[180:183], v[132:135], v[220:223]
    v_add_f32 v11, v11, v206
    v_cvt_pk_bf16_f32 v13, v207, v207
    v_and_b32 v190, v13, v224
    v_and_b32 v191, v13, v225
    v_mfma_f32_16x16x32_bf16 v[216:219], v[186:189], v[136:139], v[216:219]
    v_fma_f32 v209, v209, s45, v8
    v_exp_f32 v209, v209
    v_mfma_f32_16x16x32_bf16 v[220:223], v[184:187], v[136:139], v[220:223]
    v_add_f32 v11, v11, v207
    v_cvt_pk_bf16_f32 v13, v208, v208
    v_and_b32 v178, v13, v224
    v_and_b32 v179, v13, v225
    v_mfma_f32_16x16x32_bf16 v[216:219], v[190:193], v[140:143], v[216:219]
    v_fma_f32 v210, v210, s45, v8
    v_exp_f32 v210, v210
    v_mfma_f32_16x16x32_bf16 v[220:223], v[188:191], v[140:143], v[220:223]
    v_add_f32 v11, v11, v208
    s_waitcnt vmcnt(0)
    v_cvt_pk_bf16_f32 v13, v209, v209
    v_and_b32 v182, v13, v224
    v_and_b32 v183, v13, v225
    v_mfma_f32_16x16x32_bf16 v[216:219], v[178:181], v[144:147], v[216:219]
    v_fma_f32 v211, v211, s45, v8
    v_exp_f32 v211, v211
    v_mfma_f32_16x16x32_bf16 v[220:223], v[176:179], v[144:147], v[220:223]
    v_add_f32 v11, v11, v209
    v_cvt_pk_bf16_f32 v13, v210, v210
    v_and_b32 v186, v13, v224
    v_and_b32 v187, v13, v225
    v_mfma_f32_16x16x32_bf16 v[216:219], v[182:185], v[148:151], v[216:219]
    v_mfma_f32_16x16x32_bf16 v[220:223], v[180:183], v[148:151], v[220:223]
    v_add_f32 v11, v11, v210
    v_cvt_pk_bf16_f32 v13, v211, v211
    v_and_b32 v190, v13, v224
    v_and_b32 v191, v13, v225
    v_mfma_f32_16x16x32_bf16 v[216:219], v[186:189], v[152:155], v[216:219]
    v_mfma_f32_16x16x32_bf16 v[220:223], v[184:187], v[152:155], v[220:223]
    v_add_f32 v11, v11, v211
    v_mfma_f32_16x16x32_bf16 v[216:219], v[190:193], v[156:159], v[216:219]
    v_mfma_f32_16x16x32_bf16 v[220:223], v[188:191], v[156:159], v[220:223]
    v_mov_b32 v12, v11
    s_nop 1
    v_permlane16_swap_b32 v11, v12
    v_add_f32 v11, v11, v12
    v_mov_b32 v12, v11
    s_nop 1
    v_permlane32_swap_b32 v11, v12
    v_add_f32 v11, v11, v12
    s_mov_b64 exec, 0x1111
    ds_write_b32 v226, v11 offset:64
    s_mov_b64 exec, -1
    s_branch L_att_fin
L_att5:
    s_mov_b32 s8, s42
    s_mov_b32 s9, s43
    s_mov_b32 s10, 2097152
    s_mov_b32 s11, 0x20000
    v_lshrrev_b32 v8, 2, v2
    v_mul_u32_u24 v9, 288, v8
    v_lshl_add_u32 v9, v3, 4, v9
    v_add_u32 v9, 133184, v9
    v_lshlrev_b32 v10, 4, v8
    v_add_u32 v10, 142528, v10
    v_and_b32 v11, 1, v2
    v_lshlrev_b32 v11, 4, v11
    v_mov_b32 v12, 0xffff
    v_lshlrev_b32 v12, v11, v12
    v_and_b32 v11, 2, v2
    v_cmp_eq_u32 vcc, 0, v11
    s_nop 1
    v_cndmask_b32 v224, 0, v12, vcc
    v_xor_b32 v225, v224, v12
    s_lshl_b32 s45, s3, 2
    v_add_u32 v226, s45, v10
    s_add_u32 s57, s45, 142672
    s_add_u32 s58, s45, 142688
    v_mov_b32 v232, 142656
    s_mov_b32 s46, 1
    s_mov_b32 s47, 0
L_att5_wq:
    ds_read_b32 v228, v232
    s_add_u32 s47, s47, 1
    s_waitcnt lgkmcnt(0)
    v_cmp_ne_u32 vcc, s46, v228
    s_cmp_ge_u32 s47, 320000
    s_cbranch_scc1 L_att5_wq_x
    s_cbranch_vccnz L_att5_wq
L_att5_wq_x:
    s_setprio 2
    ds_read_b128 v[176:179], v9 offset:0
    ds_read_b128 v[180:183], v9 offset:64
    ds_read_b128 v[184:187], v9 offset:128
    ds_read_b128 v[188:191], v9 offset:192
    s_waitcnt lgkmcnt(0)
    s_waitcnt vmcnt(36)
    v_mfma_f32_16x16x32_bf16 v[196:199], v[16:19], v[176:179], 0
    v_mfma_f32_16x16x32_bf16 v[196:199], v[20:23], v[180:183], v[196:199]
    v_mfma_f32_16x16x32_bf16 v[196:199], v[24:27], v[184:187], v[196:199]
    v_mfma_f32_16x16x32_bf16 v[196:199], v[28:31], v[188:191], v[196:199]
    s_waitcnt vmcnt(32)
    v_mfma_f32_16x16x32_bf16 v[200:203], v[32:35], v[176:179], 0
    v_mfma_f32_16x16x32_bf16 v[200:203], v[36:39], v[180:183], v[200:203]
    v_mfma_f32_16x16x32_bf16 v[200:203], v[40:43], v[184:187], v[200:203]
    v_mfma_f32_16x16x32_bf16 v[200:203], v[44:47], v[188:191], v[200:203]
    s_waitcnt vmcnt(28)
    v_mfma_f32_16x16x32_bf16 v[204:207], v[48:51], v[176:179], 0
    v_mfma_f32_16x16x32_bf16 v[204:207], v[52:55], v[180:183], v[204:207]
    v_mfma_f32_16x16x32_bf16 v[204:207], v[56:59], v[184:187], v[204:207]
    v_mfma_f32_16x16x32_bf16 v[204:207], v[60:63], v[188:191], v[204:207]
    s_waitcnt vmcnt(24)
    v_mfma_f32_16x16x32_bf16 v[208:211], v[64:67], v[176:179], 0
    v_mfma_f32_16x16x32_bf16 v[208:211], v[68:71], v[180:183], v[208:211]
    v_mfma_f32_16x16x32_bf16 v[208:211], v[72:75], v[184:187], v[208:211]
    v_mfma_f32_16x16x32_bf16 v[208:211], v[76:79], v[188:191], v[208:211]
    s_waitcnt vmcnt(20)
    v_mfma_f32_16x16x32_bf16 v[212:215], v[80:83], v[176:179], 0
    v_mfma_f32_16x16x32_bf16 v[212:215], v[84:87], v[180:183], v[212:215]
    v_mfma_f32_16x16x32_bf16 v[212:215], v[88:91], v[184:187], v[212:215]
    v_mfma_f32_16x16x32_bf16 v[212:215], v[92:95], v[188:191], v[212:215]
    v_max3_f32 v8, v196, v197, v198
    v_max3_f32 v11, v199, v200, v201
    v_max3_f32 v8, v8, v202, v203
    v_max3_f32 v11, v11, v204, v205
    v_max3_f32 v8, v8, v206, v207
    v_max3_f32 v11, v11, v208, v209
    v_max3_f32 v8, v8, v210, v211
    s_nop 0
    v_max3_f32 v11, v11, v212, v213
    v_max3_f32 v8, v8, v214, v215
    v_max_f32 v8, v8, v11
    v_mov_b32 v11, v8
    s_nop 1
    v_permlane16_swap_b32 v8, v11
    v_max_f32 v8, v8, v11
    v_mov_b32 v11, v8
    s_nop 1
    v_permlane32_swap_b32 v8, v11
    v_max_f32 v8, v8, v11
    s_mov_b64 exec, 0x1111
    ds_write_b32 v226, v8
    s_mov_b64 exec, -1
    s_mov_b32 s45, 1040356334
    v_mul_f32 v8, s45, v8
    v_sub_f32 v8, 0, v8
    v_mov_b64 v[176:177], 0
    v_mov_b64 v[180:181], 0
    v_mov_b64 v[184:185], 0
    v_mov_b64 v[188:189], 0
    v_mov_b64 v[192:193], 0
    v_fma_f32 v196, v196, s45, v8
    v_exp_f32 v196, v196
    v_fma_f32 v197, v197, s45, v8
    v_exp_f32 v197, v197
    v_fma_f32 v198, v198, s45, v8
    v_exp_f32 v198, v198
    v_cvt_pk_bf16_f32 v13, v196, v196
    v_and_b32 v178, v13, v224
    v_and_b32 v179, v13, v225
    s_waitcnt vmcnt(16)
    v_cvt_pk_bf16_f32 v13, v197, v197
    v_and_b32 v182, v13, v224
    v_and_b32 v183, v13, v225
    v_mfma_f32_16x16x32_bf16 v[216:219], v[178:181], v[96:99], 0
    v_fma_f32 v199, v199, s45, v8
    v_exp_f32 v199, v199
    v_mfma_f32_16x16x32_bf16 v[220:223], v[176:179], v[96:99], 0
    v_add_f32 v11, v196, v197
    v_cvt_pk_bf16_f32 v13, v198, v198
    v_and_b32 v186, v13, v224
    v_and_b32 v187, v13, v225
    v_mfma_f32_16x16x32_bf16 v[216:219], v[182:185], v[100:103], v[216:219]
    v_fma_f32 v200, v200, s45, v8
    v_exp_f32 v200, v200
    v_mfma_f32_16x16x32_bf16 v[220:223], v[180:183], v[100:103], v[220:223]
    v_add_f32 v11, v11, v198
    v_cvt_pk_bf16_f32 v13, v199, v199
    v_and_b32 v190, v13, v224
    v_and_b32 v191, v13, v225
    v_mfma_f32_16x16x32_bf16 v[216:219], v[186:189], v[104:107], v[216:219]
    v_fma_f32 v201, v201, s45, v8
    v_exp_f32 v201, v201
    v_mfma_f32_16x16x32_bf16 v[220:223], v[184:187], v[104:107], v[220:223]
    v_add_f32 v11, v11, v199
    v_cvt_pk_bf16_f32 v13, v200, v200
    v_and_b32 v178, v13, v224
    v_and_b32 v179, v13, v225
    v_mfma_f32_16x16x32_bf16 v[216:219], v[190:193], v[108:111], v[216:219]
    v_fma_f32 v202, v202, s45, v8
    v_exp_f32 v202, v202
    v_mfma_f32_16x16x32_bf16 v[220:223], v[188:191], v[108:111], v[220:223]
    v_add_f32 v11, v11, v200
    s_waitcnt vmcnt(12)
    v_cvt_pk_bf16_f32 v13, v201, v201
    v_and_b32 v182, v13, v224
    v_and_b32 v183, v13, v225
    v_mfma_f32_16x16x32_bf16 v[216:219], v[178:181], v[112:115], v[216:219]
    v_fma_f32 v203, v203, s45, v8
    v_exp_f32 v203, v203
    v_mfma_f32_16x16x32_bf16 v[220:223], v[176:179], v[112:115], v[220:223]
    v_add_f32 v11, v11, v201
    v_cvt_pk_bf16_f32 v13, v202, v202
    v_and_b32 v186, v13, v224
    v_and_b32 v187, v13, v225
    v_mfma_f32_16x16x32_bf16 v[216:219], v[182:185], v[116:119], v[216:219]
    v_fma_f32 v204, v204, s45, v8
    v_exp_f32 v204, v204
    v_mfma_f32_16x16x32_bf16 v[220:223], v[180:183], v[116:119], v[220:223]
    v_add_f32 v11, v11, v202
    v_cvt_pk_bf16_f32 v13, v203, v203
    v_and_b32 v190, v13, v224
    v_and_b32 v191, v13, v225
    v_mfma_f32_16x16x32_bf16 v[216:219], v[186:189], v[120:123], v[216:219]
    v_fma_f32 v205, v205, s45, v8
    v_exp_f32 v205, v205
    v_mfma_f32_16x16x32_bf16 v[220:223], v[184:187], v[120:123], v[220:223]
    v_add_f32 v11, v11, v203
    v_cvt_pk_bf16_f32 v13, v204, v204
    v_and_b32 v178, v13, v224
    v_and_b32 v179, v13, v225
    v_mfma_f32_16x16x32_bf16 v[216:219], v[190:193], v[124:127], v[216:219]
    v_fma_f32 v206, v206, s45, v8
    v_exp_f32 v206, v206
    v_mfma_f32_16x16x32_bf16 v[220:223], v[188:191], v[124:127], v[220:223]
    v_add_f32 v11, v11, v204
    s_waitcnt vmcnt(8)
    v_cvt_pk_bf16_f32 v13, v205, v205
    v_and_b32 v182, v13, v224
    v_and_b32 v183, v13, v225
    v_mfma_f32_16x16x32_bf16 v[216:219], v[178:181], v[128:131], v[216:219]
    v_fma_f32 v207, v207, s45, v8
    v_exp_f32 v207, v207
    v_mfma_f32_16x16x32_bf16 v[220:223], v[176:179], v[128:131], v[220:223]
    v_add_f32 v11, v11, v205
    v_cvt_pk_bf16_f32 v13, v206, v206
    v_and_b32 v186, v13, v224
    v_and_b32 v187, v13, v225
    v_mfma_f32_16x16x32_bf16 v[216:219], v[182:185], v[132:135], v[216:219]
    v_fma_f32 v208, v208, s45, v8
    v_exp_f32 v208, v208
    v_mfma_f32_16x16x32_bf16 v[220:223], v[180:183], v[132:135], v[220:223]
    v_add_f32 v11, v11, v206
    v_cvt_pk_bf16_f32 v13, v207, v207
    v_and_b32 v190, v13, v224
    v_and_b32 v191, v13, v225
    v_mfma_f32_16x16x32_bf16 v[216:219], v[186:189], v[136:139], v[216:219]
    v_fma_f32 v209, v209, s45, v8
    v_exp_f32 v209, v209
    v_mfma_f32_16x16x32_bf16 v[220:223], v[184:187], v[136:139], v[220:223]
    v_add_f32 v11, v11, v207
    v_cvt_pk_bf16_f32 v13, v208, v208
    v_and_b32 v178, v13, v224
    v_and_b32 v179, v13, v225
    v_mfma_f32_16x16x32_bf16 v[216:219], v[190:193], v[140:143], v[216:219]
    v_fma_f32 v210, v210, s45, v8
    v_exp_f32 v210, v210
    v_mfma_f32_16x16x32_bf16 v[220:223], v[188:191], v[140:143], v[220:223]
    v_add_f32 v11, v11, v208
    s_waitcnt vmcnt(4)
    v_cvt_pk_bf16_f32 v13, v209, v209
    v_and_b32 v182, v13, v224
    v_and_b32 v183, v13, v225
    v_mfma_f32_16x16x32_bf16 v[216:219], v[178:181], v[144:147], v[216:219]
    v_fma_f32 v211, v211, s45, v8
    v_exp_f32 v211, v211
    v_mfma_f32_16x16x32_bf16 v[220:223], v[176:179], v[144:147], v[220:223]
    v_add_f32 v11, v11, v209
    v_cvt_pk_bf16_f32 v13, v210, v210
    v_and_b32 v186, v13, v224
    v_and_b32 v187, v13, v225
    v_mfma_f32_16x16x32_bf16 v[216:219], v[182:185], v[148:151], v[216:219]
    v_fma_f32 v212, v212, s45, v8
    v_exp_f32 v212, v212
    v_mfma_f32_16x16x32_bf16 v[220:223], v[180:183], v[148:151], v[220:223]
    v_add_f32 v11, v11, v210
    v_cvt_pk_bf16_f32 v13, v211, v211
    v_and_b32 v190, v13, v224
    v_and_b32 v191, v13, v225
    v_mfma_f32_16x16x32_bf16 v[216:219], v[186:189], v[152:155], v[216:219]
    v_fma_f32 v213, v213, s45, v8
    v_exp_f32 v213, v213
    v_mfma_f32_16x16x32_bf16 v[220:223], v[184:187], v[152:155], v[220:223]
    v_add_f32 v11, v11, v211
    v_cvt_pk_bf16_f32 v13, v212, v212
    v_and_b32 v178, v13, v224
    v_and_b32 v179, v13, v225
    v_mfma_f32_16x16x32_bf16 v[216:219], v[190:193], v[156:159], v[216:219]
    v_fma_f32 v214, v214, s45, v8
    v_exp_f32 v214, v214
    v_mfma_f32_16x16x32_bf16 v[220:223], v[188:191], v[156:159], v[220:223]
    v_add_f32 v11, v11, v212
    s_waitcnt vmcnt(0)
    v_cvt_pk_bf16_f32 v13, v213, v213
    v_and_b32 v182, v13, v224
    v_and_b32 v183, v13, v225
    v_mfma_f32_16x16x32_bf16 v[216:219], v[178:181], v[160:163], v[216:219]
    v_fma_f32 v215, v215, s45, v8
    v_exp_f32 v215, v215
    v_mfma_f32_16x16x32_bf16 v[220:223], v[176:179], v[160:163], v[220:223]
    v_add_f32 v11, v11, v213
    v_cvt_pk_bf16_f32 v13, v214, v214
    v_and_b32 v186, v13, v224
    v_and_b32 v187, v13, v225
    v_mfma_f32_16x16x32_bf16 v[216:219], v[182:185], v[164:167], v[216:219]
    v_mfma_f32_16x16x32_bf16 v[220:223], v[180:183], v[164:167], v[220:223]
    v_add_f32 v11, v11, v214
    v_cvt_pk_bf16_f32 v13, v215, v215
    v_and_b32 v190, v13, v224
    v_and_b32 v191, v13, v225
    v_mfma_f32_16x16x32_bf16 v[216:219], v[186:189], v[168:171], v[216:219]
    v_mfma_f32_16x16x32_bf16 v[220:223], v[184:187], v[168:171], v[220:223]
    v_add_f32 v11, v11, v215
    v_mfma_f32_16x16x32_bf16 v[216:219], v[190:193], v[172:175], v[216:219]
    v_mfma_f32_16x16x32_bf16 v[220:223], v[188:191], v[172:175], v[220:223]
    v_mov_b32 v12, v11
    s_nop 1
    v_permlane16_swap_b32 v11, v12
    v_add_f32 v11, v11, v12
    v_mov_b32 v12, v11
    s_nop 1
    v_permlane32_swap_b32 v11, v12
    v_add_f32 v11, v11, v12
    s_mov_b64 exec, 0x1111
    ds_write_b32 v226, v11 offset:64
    s_mov_b64 exec, -1
L_att_fin:
    s_lshl_b32 s45, s3, 11
    s_add_u32 s45, s45, 134336
    v_lshlrev_b32 v8, 9, v3
    v_lshl_add_u32 v8, v2, 5, v8
    v_add_u32 v8, s45, v8
    ds_write_b128 v8, v[216:219]
    ds_write_b128 v8, v[220:223] offset:16
    v_mov_b32 v228, s58
    v_mov_b32 v229, 1
    s_mov_b64 exec, 1
    ds_write_b32 v228, v229
    s_mov_b64 exec, -1
    s_lshl_b32 s45, s3, 9
    s_add_u32 s45, s45, 134336
    v_lshlrev_b32 v9, 3, v1
    v_add_u32 v9, s45, v9
    s_lshl_b32 s45, s3, 4
    s_add_u32 s45, s45, 142528
    v_mov_b32 v10, s45
    s_lshl_b32 s48, s6, 3
    s_add_u32 s48, s48, s4
    s_lshl_b32 s49, s48, 4
    s_add_u32 s49, s49, s7
    s_lshl_b32 s49, s49, 10
    s_lshl_b32 s50, s3, 8
    s_add_u32 s49, s49, s50
    s_add_u32 s49, s49, 65536
    v_lshlrev_b32 v11, 2, v1
    v_add_u32 v11, s49, v11
    s_lshl_b32 s49, s48, 2
    s_add_u32 s49, s49, s3
    s_lshl_b32 s49, s49, 4
    s_add_u32 s49, s49, s7
    s_lshl_b32 s49, s49, 3
    s_add_u32 s49, s49, 327680
    v_mov_b32 v12, s49
    v_mov_b32 v232, 142688
    s_mov_b32 s46, 1
    s_mov_b32 s47, 0
L_wred:
    ds_read_b128 v[228:231], v232
    s_add_u32 s47, s47, 1
    s_waitcnt lgkmcnt(0)
    v_xor_b32 v228, s46, v228
    v_xor_b32 v229, s46, v229
    v_xor_b32 v230, s46, v230
    v_xor_b32 v231, s46, v231
    v_or3_b32 v228, v228, v229, v230
    v_or_b32 v228, v228, v231
    v_cmp_ne_u32 vcc, 0, v228
    s_cmp_ge_u32 s47, 320000
    s_cbranch_scc1 L_wred_x
    s_cbranch_vccnz L_wred
L_wred_x:
    ds_read_b128 v[28:31], v10
    ds_read_b128 v[24:27], v10 offset:64
    ds_read_b64 v[16:17], v9
    ds_read_b64 v[18:19], v9 offset:2048
    ds_read_b64 v[20:21], v9 offset:4096
    ds_read_b64 v[22:23], v9 offset:6144
    s_mov_b32 s45, 1040356334
    s_waitcnt lgkmcnt(5)
    v_max3_f32 v32, v28, v29, v30
    v_max_f32 v32, v32, v31
    v_sub_f32 v28, v28, v32
    v_sub_f32 v29, v29, v32
    v_sub_f32 v30, v30, v32
    v_sub_f32 v31, v31, v32
    v_mul_f32 v28, s45, v28
    v_mul_f32 v29, s45, v29
    v_mul_f32 v30, s45, v30
    v_mul_f32 v31, s45, v31
    v_exp_f32 v28, v28
    v_exp_f32 v29, v29
    v_exp_f32 v30, v30
    v_exp_f32 v31, v31
    s_waitcnt lgkmcnt(4)
    v_mul_f32 v24, v24, v28
    v_fmac_f32 v24, v25, v29
    v_fmac_f32 v24, v26, v30
    v_fmac_f32 v24, v27, v31
    v_rcp_f32 v25, v24
    s_waitcnt lgkmcnt(0)
    v_mul_f32 v16, v16, v28
    v_mul_f32 v17, v17, v28
    v_fmac_f32 v16, v18, v29
    v_fmac_f32 v17, v19, v29
    v_fmac_f32 v16, v20, v30
    v_fmac_f32 v17, v21, v30
    v_fmac_f32 v16, v22, v31
    v_fmac_f32 v17, v23, v31
    v_mul_f32 v16, v16, v25
    v_mul_f32 v17, v17, v25
    v_cvt_pk_bf16_f32 v16, v16, v17
    v_min_u32 v16, -2, v16
    buffer_store_dword v16, v11, s[8:11], 0 offen sc1
    v_mul_f32 v28, s45, v32
    v_min_u32 v28, -2, v28
    v_min_u32 v29, -2, v24
    s_mov_b64 exec, 1
    buffer_store_dwordx2 v[28:29], v12, s[8:11], 0 offen sc1
    s_mov_b64 exec, -1
    s_sub_u32 s49, s5, 4
    s_cmp_lt_u32 s49, 7
    s_cbranch_scc1 L_t2
    s_cmp_eq_u32 s49, 7
    s_cbranch_scc1 L_f
    s_sub_u32 s49, s5, 12
    s_cmp_lt_u32 s49, 8
    s_cbranch_scc1 L_t1
L_fin:
    s_endpgm
L_t1:
    s_sub_u32 s49, s5, 12
    s_lshr_b32 s50, s49, 2
    s_and_b32 s51, s49, 3
    s_lshr_b32 s52, s3, 1
    s_and_b32 s53, s3, 1
    s_lshl_b32 s54, s50, 1
    s_add_u32 s54, s54, s53
    s_lshl_b32 s55, s52, 3
    s_add_u32 s55, s55, s4
    s_lshl_b32 s56, s55, 2
    s_add_u32 s56, s56, s54
    s_lshl_b32 s56, s56, 7
    s_add_u32 s56, s56, 327680
    v_add_u32 v10, v2, v3
    v_and_b32 v10, 15, v10
    v_lshlrev_b32 v10, 3, v10
    v_add_u32 v10, s56, v10
    s_lshl_b32 s56, s55, 14
    s_lshl_b32 s57, s54, 8
    s_add_u32 s56, s56, s57
    s_add_u32 s56, s56, 65536
    v_lshlrev_b32 v11, 10, v3
    v_lshl_add_u32 v11, v2, 4, v11
    v_add_u32 v11, s56, v11
    s_mov_b32 s58, 4096
    s_mov_b32 s59, 8192
    s_mov_b32 s60, 12288
    v_and_b32 v8, 1, v2
    v_lshlrev_b32 v8, 4, v8
    v_mov_b32 v9, 0xffff
    v_lshlrev_b32 v9, v8, v9
    v_bfe_u32 v8, v2, 1, 2
    v_cmp_eq_u32 vcc, 0, v8
    s_nop 1
    v_cndmask_b32 v40, 0, v9, vcc
    v_cmp_eq_u32 vcc, 1, v8
    s_nop 1
    v_cndmask_b32 v41, 0, v9, vcc
    v_cmp_eq_u32 vcc, 2, v8
    s_nop 1
    v_cndmask_b32 v42, 0, v9, vcc
    v_cmp_eq_u32 vcc, 3, v8
    s_nop 1
    v_cndmask_b32 v43, 0, v9, vcc
    s_mul_i32 s56, s52, 1040
    s_lshl_b32 s57, s53, 8
    s_add_u32 s56, s56, s57
    s_add_u32 s56, s56, 131072
    v_and_b32 v12, 1, v3
    v_lshlrev_b32 v12, 3, v12
    v_lshl_add_u32 v12, v2, 4, v12
    v_add_u32 v12, s56, v12
    s_lshl_b32 s49, s3, 2
    v_lshrrev_b32 v8, 2, v1
    v_and_b32 v15, 7, v8
    v_lshlrev_b32 v15, 1, v15
    v_xor_b32 v15, s49, v15
    v_bfe_u32 v9, v1, 1, 1
    v_add_u32 v15, v15, v9
    v_lshlrev_b32 v15, 4, v15
    v_and_b32 v9, 1, v1
    v_lshl_add_u32 v15, v9, 3, v15
    v_lshl_add_u32 v15, v8, 8, v15
    s_add_u32 s49, s49, 2
    v_lshrrev_b32 v8, 2, v1
    v_and_b32 v14, 7, v8
    v_lshlrev_b32 v14, 1, v14
    v_xor_b32 v14, s49, v14
    v_bfe_u32 v9, v1, 1, 1
    v_add_u32 v14, v14, v9
    v_lshlrev_b32 v14, 4, v14
    v_and_b32 v9, 1, v1
    v_lshl_add_u32 v14, v9, 3, v14
    v_lshl_add_u32 v14, v8, 8, v14
    v_and_b32 v13, 1, v1
    v_mul_u32_u24 v13, 1040, v13
    v_lshl_add_u32 v13, v3, 3, v13
    v_add_u32 v13, 131072, v13
    s_lshl_b32 s56, s4, 1
    s_add_u32 s56, s56, s50
    s_lshl_b32 s56, s56, 11
    s_lshl_b32 s57, s51, 8
    s_add_u32 s56, s56, s57
    s_lshl_b32 s57, s3, 6
    s_add_u32 s56, s56, s57
    s_add_u32 s56, s56, 344064
    v_and_b32 v9, 1, v1
    v_lshlrev_b32 v9, 10, v9
    v_lshl_add_u32 v9, v3, 3, v9
    v_add_u32 v9, s56, v9
    v_mov_b32 v194, 142660
    s_mov_b32 s46, 1
    s_mov_b32 s47, 0
L_t1_ww:
    ds_read_b32 v190, v194
    s_add_u32 s47, s47, 1
    s_waitcnt lgkmcnt(0)
    v_cmp_ne_u32 vcc, s46, v190
    s_cmp_ge_u32 s47, 320000
    s_cbranch_scc1 L_t1_ww_x
    s_cbranch_vccnz L_t1_ww
L_t1_ww_x:
    ds_read_b64_tr_b16 v[64:65], v15 offset:0
    ds_read_b64_tr_b16 v[66:67], v15 offset:4096
    ds_read_b64_tr_b16 v[68:69], v15 offset:8192
    ds_read_b64_tr_b16 v[70:71], v15 offset:12288
    ds_read_b64_tr_b16 v[72:73], v15 offset:16384
    ds_read_b64_tr_b16 v[74:75], v15 offset:20480
    ds_read_b64_tr_b16 v[76:77], v15 offset:24576
    ds_read_b64_tr_b16 v[78:79], v15 offset:28672
    ds_read_b64_tr_b16 v[80:81], v15 offset:32768
    ds_read_b64_tr_b16 v[82:83], v15 offset:36864
    ds_read_b64_tr_b16 v[84:85], v15 offset:40960
    ds_read_b64_tr_b16 v[86:87], v15 offset:45056
    ds_read_b64_tr_b16 v[88:89], v15 offset:49152
    ds_read_b64_tr_b16 v[90:91], v15 offset:53248
    s_waitcnt lgkmcnt(6)
    ds_read_b64_tr_b16 v[92:93], v15 offset:57344
    ds_read_b64_tr_b16 v[94:95], v15 offset:61440
    ds_read_b64_tr_b16 v[96:97], v14 offset:0
    ds_read_b64_tr_b16 v[98:99], v14 offset:4096
    ds_read_b64_tr_b16 v[100:101], v14 offset:8192
    ds_read_b64_tr_b16 v[102:103], v14 offset:12288
    ds_read_b64_tr_b16 v[104:105], v14 offset:16384
    ds_read_b64_tr_b16 v[106:107], v14 offset:20480
    ds_read_b64_tr_b16 v[108:109], v14 offset:24576
    ds_read_b64_tr_b16 v[110:111], v14 offset:28672
    ds_read_b64_tr_b16 v[112:113], v14 offset:32768
    ds_read_b64_tr_b16 v[114:115], v14 offset:36864
    ds_read_b64_tr_b16 v[116:117], v14 offset:40960
    ds_read_b64_tr_b16 v[118:119], v14 offset:45056
    ds_read_b64_tr_b16 v[120:121], v14 offset:49152
    ds_read_b64_tr_b16 v[122:123], v14 offset:53248
    s_waitcnt lgkmcnt(6)
    ds_read_b64_tr_b16 v[124:125], v14 offset:57344
    ds_read_b64_tr_b16 v[126:127], v14 offset:61440
    s_lshl_b32 s56, s55, 2
    s_add_u32 s56, s56, s54
    s_lshl_b32 s56, s56, 7
    s_add_u32 s56, s56, 327680
    s_add_u32 s62, s42, s56
    s_addc_u32 s63, s43, 0
    s_mov_b32 s57, 0
    s_waitcnt lgkmcnt(0)
L_t1_sp:
    s_load_dwordx16 s[16:31], s[62:63], 0 glc
    s_load_dwordx16 s[80:95], s[62:63], 64 glc
    s_add_u32 s57, s57, 1
    s_waitcnt lgkmcnt(0)
    s_mov_b32 s56, 0
    s_cmp_lg_u32 s17, -1
    s_addc_u32 s56, s56, 0
    s_cmp_lg_u32 s19, -1
    s_addc_u32 s56, s56, 0
    s_cmp_lg_u32 s21, -1
    s_addc_u32 s56, s56, 0
    s_cmp_lg_u32 s23, -1
    s_addc_u32 s56, s56, 0
    s_cmp_lg_u32 s25, -1
    s_addc_u32 s56, s56, 0
    s_cmp_lg_u32 s27, -1
    s_addc_u32 s56, s56, 0
    s_cmp_lg_u32 s29, -1
    s_addc_u32 s56, s56, 0
    s_cmp_lg_u32 s31, -1
    s_addc_u32 s56, s56, 0
    s_cmp_lg_u32 s81, -1
    s_addc_u32 s56, s56, 0
    s_cmp_lg_u32 s83, -1
    s_addc_u32 s56, s56, 0
    s_cmp_lg_u32 s85, -1
    s_addc_u32 s56, s56, 0
    s_cmp_lg_u32 s87, -1
    s_addc_u32 s56, s56, 0
    s_cmp_lg_u32 s89, -1
    s_addc_u32 s56, s56, 0
    s_cmp_lg_u32 s91, -1
    s_addc_u32 s56, s56, 0
    s_cmp_lg_u32 s93, -1
    s_addc_u32 s56, s56, 0
    s_cmp_lg_u32 s95, -1
    s_addc_u32 s56, s56, 0
    s_cmp_ge_u32 s57, 20000
    s_cbranch_scc1 L_t1_sp_x
    s_cmp_lt_u32 s56, 16
    s_cbranch_scc1 L_t1_sp
L_t1_sp_x:
    s_mov_b32 s47, 0
    buffer_load_dwordx2 v[16:17], v10, s[8:11], 0 offen sc1
    buffer_load_dwordx4 v[20:23], v11, s[8:11], 0 offen sc1
    buffer_load_dwordx4 v[24:27], v11, s[8:11], s58 offen sc1
    buffer_load_dwordx4 v[28:31], v11, s[8:11], s59 offen sc1
    buffer_load_dwordx4 v[32:35], v11, s[8:11], s60 offen sc1
    s_branch L_t1_chk
L_t1_poll:
    buffer_load_dwordx2 v[16:17], v10, s[8:11], 0 offen sc1
    buffer_load_dwordx4 v[20:23], v11, s[8:11], 0 offen sc1
    buffer_load_dwordx4 v[24:27], v11, s[8:11], s58 offen sc1
    buffer_load_dwordx4 v[28:31], v11, s[8:11], s59 offen sc1
    buffer_load_dwordx4 v[32:35], v11, s[8:11], s60 offen sc1
L_t1_chk:
    s_add_u32 s47, s47, 1
    s_waitcnt vmcnt(0)
    v_max3_u32 v18, v16, v17, v20
    v_max3_u32 v19, v21, v22, v23
    v_max3_u32 v18, v18, v24, v25
    v_max3_u32 v19, v19, v26, v27
    v_max3_u32 v18, v18, v28, v29
    v_max3_u32 v19, v19, v30, v31
    v_max3_u32 v18, v18, v32, v33
    v_max3_u32 v19, v19, v34, v35
    v_max_u32 v18, v18, v19
    v_cmp_eq_u32 vcc, -1, v18
    s_cmp_ge_u32 s47, 20000
    s_cbranch_scc1 L_t1_poll_x
    s_cbranch_vccz L_t1_poll_x
    s_mov_b64 exec, vcc
    s_branch L_t1_poll
L_t1_poll_x:
    s_mov_b64 exec, -1
    v_mov_b32 v18, v16
    s_nop 1
    v_max_f32_dpp v18, v18, v18 row_ror:8 row_mask:0xf bank_mask:0xf
    s_nop 1
    v_max_f32_dpp v18, v18, v18 row_ror:4 row_mask:0xf bank_mask:0xf
    s_nop 1
    v_max_f32_dpp v18, v18, v18 row_ror:2 row_mask:0xf bank_mask:0xf
    s_nop 1
    v_max_f32_dpp v18, v18, v18 row_ror:1 row_mask:0xf bank_mask:0xf
    v_sub_f32 v16, v16, v18
    v_exp_f32 v16, v16
    s_nop 0
    v_mul_f32 v16, v16, v17
    v_cvt_pk_bf16_f32 v19, v16, v16
    v_lshlrev_b32 v18, 16, v19
    s_nop 0
    v_mov_b32_dpp v17, v19 row_newbcast:0 row_mask:0xf bank_mask:0xf
    v_add_f32_dpp v18, v18, v18 row_ror:8 row_mask:0xf bank_mask:0xf
    v_and_b32 v44, v17, v40
    v_and_b32 v45, v17, v41
    v_and_b32 v46, v17, v42
    v_and_b32 v47, v17, v43
    s_nop 1
    v_mfma_f32_16x16x32_bf16 v[36:39], v[44:47], v[20:23], 0
    v_mov_b32_dpp v17, v19 row_newbcast:4 row_mask:0xf bank_mask:0xf
    v_add_f32_dpp v18, v18, v18 row_ror:4 row_mask:0xf bank_mask:0xf
    v_and_b32 v48, v17, v40
    v_and_b32 v49, v17, v41
    v_and_b32 v50, v17, v42
    v_and_b32 v51, v17, v43
    s_nop 1
    v_mfma_f32_16x16x32_bf16 v[36:39], v[48:51], v[24:27], v[36:39]
    v_mov_b32_dpp v17, v19 row_newbcast:8 row_mask:0xf bank_mask:0xf
    v_add_f32_dpp v18, v18, v18 row_ror:2 row_mask:0xf bank_mask:0xf
    v_and_b32 v52, v17, v40
    v_and_b32 v53, v17, v41
    v_and_b32 v54, v17, v42
    v_and_b32 v55, v17, v43
    s_nop 1
    v_mfma_f32_16x16x32_bf16 v[36:39], v[52:55], v[28:31], v[36:39]
    v_mov_b32_dpp v17, v19 row_newbcast:12 row_mask:0xf bank_mask:0xf
    v_add_f32_dpp v18, v18, v18 row_ror:1 row_mask:0xf bank_mask:0xf
    v_and_b32 v56, v17, v40
    v_and_b32 v57, v17, v41
    v_and_b32 v58, v17, v42
    v_and_b32 v59, v17, v43
    s_nop 1
    v_mfma_f32_16x16x32_bf16 v[36:39], v[56:59], v[32:35], v[36:39]
    v_rcp_f32 v18, v18
    s_nop 6
    v_mul_f32 v36, v36, v18
    v_mul_f32 v37, v37, v18
    v_mul_f32 v38, v38, v18
    v_mul_f32 v39, v39, v18
    v_cvt_pk_bf16_f32 v36, v36, v37
    v_cvt_pk_bf16_f32 v37, v38, v39
    s_mov_b32 exec_hi, 0
    ds_write_b64 v12, v[36:37]
    s_mov_b64 exec, -1
    s_waitcnt lgkmcnt(0)
    s_barrier
    ds_read2_b64 v[128:131], v13 offset0:0 offset1:4
    ds_read2_b64 v[132:135], v13 offset0:8 offset1:12
    ds_read2_b64 v[136:139], v13 offset0:16 offset1:20
    ds_read2_b64 v[140:143], v13 offset0:24 offset1:28
    ds_read2_b64 v[144:147], v13 offset0:32 offset1:36
    ds_read2_b64 v[148:151], v13 offset0:40 offset1:44
    ds_read2_b64 v[152:155], v13 offset0:48 offset1:52
    ds_read2_b64 v[156:159], v13 offset0:56 offset1:60
    s_waitcnt lgkmcnt(7)
    v_mfma_f32_16x16x32_bf16 v[56:59], v[64:67], v[128:131], 0
    v_mfma_f32_16x16x32_bf16 v[60:63], v[96:99], v[128:131], 0
    s_waitcnt lgkmcnt(6)
    v_mfma_f32_16x16x32_bf16 v[56:59], v[68:71], v[132:135], v[56:59]
    v_mfma_f32_16x16x32_bf16 v[60:63], v[100:103], v[132:135], v[60:63]
    s_waitcnt lgkmcnt(5)
    v_mfma_f32_16x16x32_bf16 v[56:59], v[72:75], v[136:139], v[56:59]
    v_mfma_f32_16x16x32_bf16 v[60:63], v[104:107], v[136:139], v[60:63]
    s_waitcnt lgkmcnt(4)
    v_mfma_f32_16x16x32_bf16 v[56:59], v[76:79], v[140:143], v[56:59]
    v_mfma_f32_16x16x32_bf16 v[60:63], v[108:111], v[140:143], v[60:63]
    s_waitcnt lgkmcnt(3)
    v_mfma_f32_16x16x32_bf16 v[56:59], v[80:83], v[144:147], v[56:59]
    v_mfma_f32_16x16x32_bf16 v[60:63], v[112:115], v[144:147], v[60:63]
    s_waitcnt lgkmcnt(2)
    v_mfma_f32_16x16x32_bf16 v[56:59], v[84:87], v[148:151], v[56:59]
    v_mfma_f32_16x16x32_bf16 v[60:63], v[116:119], v[148:151], v[60:63]
    s_waitcnt lgkmcnt(1)
    v_mfma_f32_16x16x32_bf16 v[56:59], v[88:91], v[152:155], v[56:59]
    v_mfma_f32_16x16x32_bf16 v[60:63], v[120:123], v[152:155], v[60:63]
    s_waitcnt lgkmcnt(0)
    v_mfma_f32_16x16x32_bf16 v[56:59], v[92:95], v[156:159], v[56:59]
    v_mfma_f32_16x16x32_bf16 v[60:63], v[124:127], v[156:159], v[60:63]
    s_nop 6
    v_cvt_pk_bf16_f32 v56, v56, v57
    v_cvt_pk_bf16_f32 v57, v58, v59
    v_cvt_pk_bf16_f32 v60, v60, v61
    v_cvt_pk_bf16_f32 v61, v62, v63
    v_min_u32 v56, -2, v56
    v_min_u32 v57, -2, v57
    v_min_u32 v60, -2, v60
    v_min_u32 v61, -2, v61
    s_mov_b32 exec_lo, 0x00030003
    s_mov_b32 exec_hi, 0x00030003
    buffer_store_dwordx2 v[56:57], v9, s[8:11], 0 offen sc1
    buffer_store_dwordx2 v[60:61], v9, s[8:11], 0 offen offset:32 sc1
    s_mov_b64 exec, -1
    s_endpgm
L_t2:
    s_mul_i32 s48, s4, 7
    s_add_u32 s48, s48, s5
    s_sub_u32 s48, s48, 4
    s_lshr_b32 s52, s3, 1
    s_and_b32 s53, s3, 1
    s_lshl_b32 s56, s52, 10
    s_lshl_b32 s57, s53, 9
    s_add_u32 s56, s56, s57
    s_add_u32 s57, s56, 344064
    v_lshlrev_b32 v10, 11, v3
    v_lshl_add_u32 v10, v2, 4, v10
    v_add_u32 v10, s57, v10
    s_mov_b32 s58, 8192
    s_mov_b32 s59, 16384
    s_mov_b32 s60, 24576
    s_mov_b32 s61, 4096
    v_and_b32 v11, 1, v3
    v_lshlrev_b32 v11, 3, v11
    v_lshl_add_u32 v11, v2, 4, v11
    v_add_u32 v11, s56, v11
    v_add_u32 v12, 49152, v11
    global_load_dwordx2 v[44:45], v11, s[16:17]
    global_load_dwordx2 v[46:47], v11, s[16:17] offset:256
    s_mov_b32 s47, 0
L_t2_pm:
    buffer_load_dwordx2 v[80:81], v12, s[8:11], 0 offen offset:0 sc1
    buffer_load_dwordx2 v[82:83], v12, s[8:11], 0 offen offset:2048 sc1
    buffer_load_dwordx2 v[84:85], v12, s[8:11], s61 offen offset:0 sc1
    buffer_load_dwordx2 v[86:87], v12, s[8:11], 0 offen offset:256 sc1
    buffer_load_dwordx2 v[88:89], v12, s[8:11], 0 offen offset:2304 sc1
    buffer_load_dwordx2 v[90:91], v12, s[8:11], s61 offen offset:256 sc1
    s_add_u32 s47, s47, 1
    s_waitcnt vmcnt(0)
    v_max3_u32 v18, v80, v81, v82
    v_max3_u32 v19, v83, v84, v85
    v_max3_u32 v18, v18, v86, v87
    v_max3_u32 v19, v19, v88, v89
    v_max3_u32 v18, v18, v90, v91
    v_max_u32 v18, v18, v19
    v_cmp_eq_u32 vcc, -1, v18
    s_cmp_ge_u32 s47, 20000
    s_cbranch_scc1 L_t2_pm_x
    s_cbranch_vccz L_t2_pm_x
    s_mov_b64 exec, vcc
    s_branch L_t2_pm
L_t2_pm_x:
    s_mov_b64 exec, -1
    v_and_b32 v8, 1, v2
    v_lshlrev_b32 v8, 4, v8
    v_mov_b32 v9, 0xffff
    v_lshlrev_b32 v9, v8, v9
    v_bfe_u32 v8, v2, 1, 2
    v_cmp_eq_u32 vcc, 0, v8
    s_nop 1
    v_cndmask_b32 v40, 0, v9, vcc
    v_cmp_eq_u32 vcc, 1, v8
    s_nop 1
    v_cndmask_b32 v41, 0, v9, vcc
    v_cmp_eq_u32 vcc, 2, v8
    s_nop 1
    v_cndmask_b32 v42, 0, v9, vcc
    v_cmp_eq_u32 vcc, 3, v8
    s_nop 1
    v_cndmask_b32 v43, 0, v9, vcc
    s_mov_b32 s56, 0x3f803f80
    v_and_b32 v40, s56, v40
    v_and_b32 v41, s56, v41
    v_and_b32 v42, s56, v42
    v_and_b32 v43, s56, v43
    v_lshlrev_b32 v100, 16, v44
    v_and_b32 v101, 0xffff0000, v44
    v_lshlrev_b32 v102, 16, v45
    v_and_b32 v103, 0xffff0000, v45
    v_lshlrev_b32 v108, 16, v80
    v_and_b32 v109, 0xffff0000, v80
    v_lshlrev_b32 v110, 16, v81
    v_and_b32 v111, 0xffff0000, v81
    v_lshlrev_b32 v116, 16, v84
    v_and_b32 v117, 0xffff0000, v84
    v_lshlrev_b32 v118, 16, v85
    v_and_b32 v119, 0xffff0000, v85
    v_lshlrev_b32 v104, 16, v46
    v_and_b32 v105, 0xffff0000, v46
    v_lshlrev_b32 v106, 16, v47
    v_and_b32 v107, 0xffff0000, v47
    v_lshlrev_b32 v112, 16, v86
    v_and_b32 v113, 0xffff0000, v86
    v_lshlrev_b32 v114, 16, v87
    v_and_b32 v115, 0xffff0000, v87
    v_lshlrev_b32 v120, 16, v90
    v_and_b32 v121, 0xffff0000, v90
    v_lshlrev_b32 v122, 16, v91
    v_and_b32 v123, 0xffff0000, v91
    v_add_f32 v116, 1.0, v116
    v_add_f32 v117, 1.0, v117
    v_add_f32 v118, 1.0, v118
    v_add_f32 v119, 1.0, v119
    v_add_f32 v120, 1.0, v120
    v_add_f32 v121, 1.0, v121
    v_add_f32 v122, 1.0, v122
    v_add_f32 v123, 1.0, v123
    v_cvt_pk_bf16_f32 v20, v116, v117
    v_cvt_pk_bf16_f32 v21, v118, v119
    v_cvt_pk_bf16_f32 v22, v120, v121
    v_cvt_pk_bf16_f32 v23, v122, v123
    v_lshlrev_b32 v116, 16, v20
    v_and_b32 v117, 0xffff0000, v20
    v_lshlrev_b32 v118, 16, v21
    v_and_b32 v119, 0xffff0000, v21
    v_lshlrev_b32 v120, 16, v22
    v_and_b32 v121, 0xffff0000, v22
    v_lshlrev_b32 v122, 16, v23
    v_and_b32 v123, 0xffff0000, v23
    s_lshl_b32 s57, s52, 4
    s_add_u32 s57, s57, 143808
    v_add_u32 v13, s57, v11
    v_mov_b32 v16, v13
    s_mov_b32 exec_hi, 0
    ds_write_b64 v16, v[20:21] offset:2080
    ds_write_b64 v16, v[22:23] offset:2336
    ds_write_b64 v16, v[82:83] offset:4160
    ds_write_b64 v16, v[88:89] offset:4416
    s_mov_b64 exec, -1
    s_lshl_b32 s49, s53, 1
    v_lshrrev_b32 v8, 2, v1
    v_and_b32 v15, 1, v3
    v_lshlrev_b32 v15, 1, v15
    v_xor_b32 v15, s49, v15
    v_bfe_u32 v9, v1, 1, 1
    v_add_u32 v15, v15, v9
    v_lshlrev_b32 v15, 4, v15
    v_and_b32 v9, 1, v1
    v_lshl_add_u32 v15, v9, 3, v15
    v_lshl_add_u32 v15, v8, 6, v15
    s_lshl_b32 s57, s52, 15
    s_add_u32 s57, s57, 0
    v_add_u32 v15, s57, v15
    v_and_b32 v14, 1, v1
    v_mul_u32_u24 v14, 1040, v14
    v_lshl_add_u32 v14, v3, 3, v14
    v_add_u32 v14, 131072, v14
    v_bfe_u32 v16, v1, 1, 1
    v_lshlrev_b32 v16, 11, v16
    v_and_b32 v17, 1, v1
    v_lshl_add_u32 v16, v17, 10, v16
    v_lshl_add_u32 v16, v3, 3, v16
    v_add_u32 v16, 143808, v16
    v_lshrrev_b32 v20, 2, v1
    v_and_b32 v21, 7, v20
    v_lshlrev_b32 v21, 5, v21
    v_bfe_u32 v22, v1, 1, 1
    v_lshl_add_u32 v21, v22, 4, v21
    v_and_b32 v22, 1, v1
    v_lshl_add_u32 v21, v22, 3, v21
    v_lshl_add_u32 v21, v20, 10, v21
    s_lshl_b32 s57, s3, 8
    s_add_u32 s57, s57, 65536
    v_add_u32 v21, s57, v21
    v_and_b32 v18, 1, v1
    v_lshlrev_b32 v18, 7, v18
    v_lshl_add_u32 v18, v3, 4, v18
    v_add_u32 v19, 142784, v18
    s_lshl_b32 s57, s52, 8
    s_lshl_b32 s56, s53, 6
    s_add_u32 s57, s57, s56
    v_add_u32 v18, s57, v19
    s_lshl_b32 s57, s3, 3
    s_add_u32 s57, s57, 143296
    v_mov_b32 v23, s57
    v_and_b32 v24, 1, v1
    v_lshlrev_b32 v24, 4, v24
    v_add_u32 v24, 143296, v24
    s_lshl_b32 s56, s48, 11
    s_lshl_b32 s57, s3, 8
    s_add_u32 s56, s56, s57
    s_add_u32 s56, s56, 393216
    v_and_b32 v25, 1, v2
    v_lshlrev_b32 v25, 10, v25
    v_lshrrev_b32 v26, 1, v2
    v_lshl_add_u32 v25, v26, 5, v25
    v_lshl_add_u32 v25, v3, 3, v25
    v_add_u32 v25, s56, v25
    v_mov_b32 v194, 142660
    s_mov_b32 s46, 1
    s_mov_b32 s47, 0
L_t2_ww:
    ds_read_b32 v190, v194
    s_add_u32 s47, s47, 1
    s_waitcnt lgkmcnt(0)
    v_cmp_ne_u32 vcc, s46, v190
    s_cmp_ge_u32 s47, 320000
    s_cbranch_scc1 L_t2_ww_x
    s_cbranch_vccnz L_t2_ww
L_t2_ww_x:
    s_mov_b32 s47, 0
    buffer_load_dwordx4 v[48:51], v10, s[8:11], 0 offen offset:0 sc1
    buffer_load_dwordx4 v[52:55], v10, s[8:11], s58 offen offset:0 sc1
    buffer_load_dwordx4 v[56:59], v10, s[8:11], s59 offen offset:0 sc1
    buffer_load_dwordx4 v[60:63], v10, s[8:11], s60 offen offset:0 sc1
    buffer_load_dwordx4 v[64:67], v10, s[8:11], 0 offen offset:256 sc1
    buffer_load_dwordx4 v[68:71], v10, s[8:11], s58 offen offset:256 sc1
    buffer_load_dwordx4 v[72:75], v10, s[8:11], s59 offen offset:256 sc1
    buffer_load_dwordx4 v[76:79], v10, s[8:11], s60 offen offset:256 sc1
    ds_read_b64_tr_b16 v[128:129], v15 offset:0
    ds_read_b64_tr_b16 v[130:131], v15 offset:1024
    ds_read_b64_tr_b16 v[132:133], v15 offset:2048
    ds_read_b64_tr_b16 v[134:135], v15 offset:3072
    ds_read_b64_tr_b16 v[136:137], v15 offset:4096
    ds_read_b64_tr_b16 v[138:139], v15 offset:5120
    ds_read_b64_tr_b16 v[140:141], v15 offset:6144
    ds_read_b64_tr_b16 v[142:143], v15 offset:7168
    ds_read_b64_tr_b16 v[144:145], v15 offset:8192
    ds_read_b64_tr_b16 v[146:147], v15 offset:9216
    ds_read_b64_tr_b16 v[148:149], v15 offset:10240
    ds_read_b64_tr_b16 v[150:151], v15 offset:11264
    ds_read_b64_tr_b16 v[152:153], v15 offset:12288
    ds_read_b64_tr_b16 v[154:155], v15 offset:13312
    s_waitcnt lgkmcnt(6)
    ds_read_b64_tr_b16 v[156:157], v15 offset:14336
    ds_read_b64_tr_b16 v[158:159], v15 offset:15360
    ds_read_b64_tr_b16 v[160:161], v15 offset:16384
    ds_read_b64_tr_b16 v[162:163], v15 offset:17408
    ds_read_b64_tr_b16 v[164:165], v15 offset:18432
    ds_read_b64_tr_b16 v[166:167], v15 offset:19456
    ds_read_b64_tr_b16 v[168:169], v15 offset:20480
    ds_read_b64_tr_b16 v[170:171], v15 offset:21504
    s_waitcnt lgkmcnt(6)
    ds_read_b64_tr_b16 v[172:173], v15 offset:22528
    ds_read_b64_tr_b16 v[174:175], v15 offset:23552
    ds_read_b64_tr_b16 v[176:177], v15 offset:24576
    ds_read_b64_tr_b16 v[178:179], v15 offset:25600
    ds_read_b64_tr_b16 v[180:181], v15 offset:26624
    ds_read_b64_tr_b16 v[182:183], v15 offset:27648
    ds_read_b64_tr_b16 v[184:185], v15 offset:28672
    ds_read_b64_tr_b16 v[186:187], v15 offset:29696
    s_waitcnt lgkmcnt(6)
    ds_read_b64_tr_b16 v[188:189], v15 offset:30720
    ds_read_b64_tr_b16 v[190:191], v15 offset:31744
    v_xor_b32 v22, 0, v21
    ds_read_b64_tr_b16 v[192:193], v22
    ds_read_b64_tr_b16 v[194:195], v22 offset:16384
    v_xor_b32 v22, 32, v21
    ds_read_b64_tr_b16 v[196:197], v22
    ds_read_b64_tr_b16 v[198:199], v22 offset:16384
    v_xor_b32 v22, 64, v21
    ds_read_b64_tr_b16 v[200:201], v22
    ds_read_b64_tr_b16 v[202:203], v22 offset:16384
    s_waitcnt lgkmcnt(4)
    v_xor_b32 v22, 96, v21
    ds_read_b64_tr_b16 v[204:205], v22
    ds_read_b64_tr_b16 v[206:207], v22 offset:16384
    v_xor_b32 v22, 128, v21
    ds_read_b64_tr_b16 v[208:209], v22
    ds_read_b64_tr_b16 v[210:211], v22 offset:16384
    v_xor_b32 v22, 160, v21
    ds_read_b64_tr_b16 v[212:213], v22
    ds_read_b64_tr_b16 v[214:215], v22 offset:16384
    s_waitcnt lgkmcnt(4)
    v_xor_b32 v22, 192, v21
    ds_read_b64_tr_b16 v[216:217], v22
    ds_read_b64_tr_b16 v[218:219], v22 offset:16384
    v_xor_b32 v22, 224, v21
    ds_read_b64_tr_b16 v[220:221], v22
    ds_read_b64_tr_b16 v[222:223], v22 offset:16384
    v_lshrrev_b32 v16, 1, v2
    v_min_u32 v16, 2, v16
    v_and_b32 v17, 1, v1
    v_lshl_add_u32 v16, v16, 1, v17
    v_mul_u32_u24 v16, 1040, v16
    v_add_u32 v16, 143808, v16
    v_lshl_add_u32 v14, v3, 3, v16
    s_branch L_t2_chk
L_t2_poll:
    buffer_load_dwordx4 v[48:51], v10, s[8:11], 0 offen offset:0 sc1
    buffer_load_dwordx4 v[52:55], v10, s[8:11], s58 offen offset:0 sc1
    buffer_load_dwordx4 v[56:59], v10, s[8:11], s59 offen offset:0 sc1
    buffer_load_dwordx4 v[60:63], v10, s[8:11], s60 offen offset:0 sc1
    buffer_load_dwordx4 v[64:67], v10, s[8:11], 0 offen offset:256 sc1
    buffer_load_dwordx4 v[68:71], v10, s[8:11], s58 offen offset:256 sc1
    buffer_load_dwordx4 v[72:75], v10, s[8:11], s59 offen offset:256 sc1
    buffer_load_dwordx4 v[76:79], v10, s[8:11], s60 offen offset:256 sc1
L_t2_chk:
    s_add_u32 s47, s47, 1
    s_waitcnt vmcnt(0)
    v_max3_u32 v36, v48, v49, v50
    v_max3_u32 v37, v51, v52, v53
    v_max3_u32 v36, v36, v54, v55
    v_max3_u32 v37, v37, v56, v57
    v_max3_u32 v36, v36, v58, v59
    v_max3_u32 v37, v37, v60, v61
    v_max3_u32 v36, v36, v62, v63
    v_max3_u32 v37, v37, v64, v65
    v_max3_u32 v36, v36, v66, v67
    v_max3_u32 v37, v37, v68, v69
    v_max3_u32 v36, v36, v70, v71
    v_max3_u32 v37, v37, v72, v73
    v_max3_u32 v36, v36, v74, v75
    v_max3_u32 v37, v37, v76, v77
    v_max3_u32 v36, v36, v78, v79
    v_max_u32 v36, v36, v37
    v_cmp_eq_u32 vcc, -1, v36
    s_cmp_ge_u32 s47, 20000
    s_cbranch_scc1 L_t2_poll_x
    s_cbranch_vccz L_t2_poll_x
    s_mov_b64 exec, vcc
    s_branch L_t2_poll
L_t2_poll_x:
    s_mov_b64 exec, -1
    v_mfma_f32_16x16x32_bf16 v[92:95], v[40:43], v[48:51], 0
    v_mfma_f32_16x16x32_bf16 v[96:99], v[40:43], v[64:67], 0
    v_mfma_f32_16x16x32_bf16 v[92:95], v[40:43], v[52:55], v[92:95]
    v_mfma_f32_16x16x32_bf16 v[96:99], v[40:43], v[68:71], v[96:99]
    v_mfma_f32_16x16x32_bf16 v[92:95], v[40:43], v[56:59], v[92:95]
    v_mfma_f32_16x16x32_bf16 v[96:99], v[40:43], v[72:75], v[96:99]
    v_mfma_f32_16x16x32_bf16 v[92:95], v[40:43], v[60:63], v[92:95]
    v_mfma_f32_16x16x32_bf16 v[96:99], v[40:43], v[76:79], v[96:99]
    s_nop 6
    v_fma_f32 v92, v92, v108, v100
    v_fma_f32 v93, v93, v109, v101
    v_fma_f32 v94, v94, v110, v102
    v_fma_f32 v95, v95, v111, v103
    v_fma_f32 v96, v96, v112, v104
    v_fma_f32 v97, v97, v113, v105
    v_fma_f32 v98, v98, v114, v106
    v_fma_f32 v99, v99, v115, v107
    v_mul_f32 v100, v92, v116
    v_mul_f32 v101, v93, v117
    v_mul_f32 v102, v94, v118
    v_mul_f32 v103, v95, v119
    v_mul_f32 v104, v96, v120
    v_mul_f32 v105, v97, v121
    v_mul_f32 v106, v98, v122
    v_mul_f32 v107, v99, v123
    v_cvt_pk_bf16_f32 v100, v100, v101
    v_cvt_pk_bf16_f32 v101, v102, v103
    v_cvt_pk_bf16_f32 v104, v104, v105
    v_cvt_pk_bf16_f32 v105, v106, v107
    s_mov_b32 exec_hi, 0
    ds_write_b64 v13, v[100:101]
    ds_write_b64 v13, v[104:105] offset:256
    s_mov_b64 exec, -1
    v_add_f32 v36, v92, v93
    v_mul_f32 v37, v92, v92
    v_add_f32 v38, v94, v95
    v_mul_f32 v39, v93, v93
    v_fmac_f32 v37, v94, v94
    v_fmac_f32 v39, v95, v95
    v_fmac_f32 v37, v96, v96
    v_fmac_f32 v39, v97, v97
    v_fmac_f32 v37, v98, v98
    v_fmac_f32 v39, v99, v99
    v_add_f32 v36, v36, v96
    v_add_f32 v38, v38, v97
    v_add_f32 v36, v36, v98
    v_add_f32 v38, v38, v99
    v_add_f32 v36, v36, v38
    v_add_f32 v37, v37, v39
    s_nop 0
    v_add_f32_dpp v36, v36, v36 row_ror:8 row_mask:0xf bank_mask:0xf
    v_add_f32_dpp v37, v37, v37 row_ror:8 row_mask:0xf bank_mask:0xf
    s_nop 0
    v_add_f32_dpp v36, v36, v36 row_ror:4 row_mask:0xf bank_mask:0xf
    v_add_f32_dpp v37, v37, v37 row_ror:4 row_mask:0xf bank_mask:0xf
    s_nop 0
    v_add_f32_dpp v36, v36, v36 row_ror:2 row_mask:0xf bank_mask:0xf
    v_add_f32_dpp v37, v37, v37 row_ror:2 row_mask:0xf bank_mask:0xf
    s_nop 0
    v_add_f32_dpp v36, v36, v36 row_ror:1 row_mask:0xf bank_mask:0xf
    v_add_f32_dpp v37, v37, v37 row_ror:1 row_mask:0xf bank_mask:0xf
    v_mov_b32 v38, v36
    v_mov_b32 v39, v37
    s_nop 0
    v_permlane16_swap_b32 v36, v38
    v_permlane16_swap_b32 v37, v39
    v_add_f32 v36, v36, v38
    v_add_f32 v37, v37, v39
    s_mov_b64 exec, 1
    ds_write_b64 v23, v[36:37]
    s_mov_b64 exec, -1
    s_waitcnt lgkmcnt(0)
    s_barrier
    ds_read_b128 v[36:39], v24
    ds_read2_b64 v[48:51], v14 offset0:0 offset1:4
    ds_read2_b64 v[52:55], v14 offset0:8 offset1:12
    ds_read2_b64 v[56:59], v14 offset0:16 offset1:20
    ds_read2_b64 v[60:63], v14 offset0:24 offset1:28
    ds_read2_b64 v[64:67], v14 offset0:32 offset1:36
    ds_read2_b64 v[68:71], v14 offset0:40 offset1:44
    ds_read2_b64 v[72:75], v14 offset0:48 offset1:52
    ds_read2_b64 v[76:79], v14 offset0:56 offset1:60
    ds_read2_b64 v[96:99], v14 offset0:64 offset1:68
    ds_read2_b64 v[100:103], v14 offset0:72 offset1:76
    ds_read2_b64 v[104:107], v14 offset0:80 offset1:84
    ds_read2_b64 v[108:111], v14 offset0:88 offset1:92
    ds_read2_b64 v[112:115], v14 offset0:96 offset1:100
    ds_read2_b64 v[116:119], v14 offset0:104 offset1:108
    s_waitcnt lgkmcnt(13)
    v_mfma_f32_16x16x32_bf16 v[92:95], v[128:131], v[48:51], 0
    ds_read2_b64 v[120:123], v14 offset0:112 offset1:116
    s_waitcnt lgkmcnt(13)
    v_mfma_f32_16x16x32_bf16 v[92:95], v[132:135], v[52:55], v[92:95]
    ds_read2_b64 v[124:127], v14 offset0:120 offset1:124
    s_waitcnt lgkmcnt(13)
    v_mfma_f32_16x16x32_bf16 v[92:95], v[136:139], v[56:59], v[92:95]
    s_mov_b32 s57, 989855744
    v_add_f32 v36, v36, v38
    v_add_f32 v37, v37, v39
    v_mul_f32 v36, s57, v36
    v_mul_f32 v37, s57, v37
    s_waitcnt lgkmcnt(12)
    v_mfma_f32_16x16x32_bf16 v[92:95], v[140:143], v[60:63], v[92:95]
    s_waitcnt lgkmcnt(11)
    v_mfma_f32_16x16x32_bf16 v[92:95], v[144:147], v[64:67], v[92:95]
    v_fma_f32 v37, -v36, v36, v37
    v_add_f32 v37, 0x3727c5ac, v37
    v_rsq_f32 v37, v37
    s_waitcnt lgkmcnt(10)
    v_mfma_f32_16x16x32_bf16 v[92:95], v[148:151], v[68:71], v[92:95]
    s_waitcnt lgkmcnt(9)
    v_mfma_f32_16x16x32_bf16 v[92:95], v[152:155], v[72:75], v[92:95]
    v_mul_f32 v36, v36, v37
    s_waitcnt lgkmcnt(8)
    v_mfma_f32_16x16x32_bf16 v[92:95], v[156:159], v[76:79], v[92:95]
    s_waitcnt lgkmcnt(7)
    v_mfma_f32_16x16x32_bf16 v[92:95], v[160:163], v[96:99], v[92:95]
    s_waitcnt lgkmcnt(6)
    v_mfma_f32_16x16x32_bf16 v[92:95], v[164:167], v[100:103], v[92:95]
    s_waitcnt lgkmcnt(5)
    v_mfma_f32_16x16x32_bf16 v[92:95], v[168:171], v[104:107], v[92:95]
    s_waitcnt lgkmcnt(4)
    v_mfma_f32_16x16x32_bf16 v[92:95], v[172:175], v[108:111], v[92:95]
    s_waitcnt lgkmcnt(3)
    v_mfma_f32_16x16x32_bf16 v[92:95], v[176:179], v[112:115], v[92:95]
    s_waitcnt lgkmcnt(2)
    v_mfma_f32_16x16x32_bf16 v[92:95], v[180:183], v[116:119], v[92:95]
    s_waitcnt lgkmcnt(1)
    v_mfma_f32_16x16x32_bf16 v[92:95], v[184:187], v[120:123], v[92:95]
    s_waitcnt lgkmcnt(0)
    v_mfma_f32_16x16x32_bf16 v[92:95], v[188:191], v[124:127], v[92:95]
    s_nop 7
    v_mov_b32_dpp v28, v92 row_shl:2 row_mask:0xf bank_mask:0xf
    v_mov_b32_dpp v29, v93 row_shl:2 row_mask:0xf bank_mask:0xf
    v_mov_b32_dpp v30, v94 row_shl:2 row_mask:0xf bank_mask:0xf
    v_mov_b32_dpp v31, v95 row_shl:2 row_mask:0xf bank_mask:0xf
    v_mov_b32_dpp v32, v92 row_shl:4 row_mask:0xf bank_mask:0xf
    v_mov_b32_dpp v33, v93 row_shl:4 row_mask:0xf bank_mask:0xf
    v_mov_b32_dpp v34, v94 row_shl:4 row_mask:0xf bank_mask:0xf
    v_mov_b32_dpp v35, v95 row_shl:4 row_mask:0xf bank_mask:0xf
    v_fma_f32 v32, -v36, v28, v32
    v_fma_f32 v33, -v36, v29, v33
    v_fma_f32 v34, -v36, v30, v34
    v_fma_f32 v35, -v36, v31, v35
    v_fma_f32 v92, v92, v37, v32
    v_fma_f32 v93, v93, v37, v33
    v_fma_f32 v94, v94, v37, v34
    v_fma_f32 v95, v95, v37, v35
    s_mov_b32 exec_lo, 0x00030003
    s_mov_b32 exec_hi, 0x00030003
    ds_write_b128 v18, v[92:95]
    s_mov_b64 exec, -1
    s_waitcnt lgkmcnt(0)
    s_barrier
    ds_read_b128 v[48:51], v19
    ds_read_b128 v[52:55], v19 offset:64
    ds_read_b128 v[56:59], v19 offset:256
    ds_read_b128 v[60:63], v19 offset:320
    v_mov_b64 v[96:97], 0
    v_mov_b64 v[98:99], 0
    v_mov_b64 v[100:101], 0
    v_mov_b64 v[102:103], 0
    v_mov_b64 v[104:105], 0
    v_mov_b64 v[106:107], 0
    v_mov_b64 v[108:109], 0
    v_mov_b64 v[110:111], 0
    v_mov_b64 v[112:113], 0
    v_mov_b64 v[114:115], 0
    v_mov_b64 v[116:117], 0
    v_mov_b64 v[118:119], 0
    v_mov_b64 v[120:121], 0
    v_mov_b64 v[122:123], 0
    v_mov_b64 v[124:125], 0
    v_mov_b64 v[126:127], 0
    s_waitcnt lgkmcnt(0)
    v_mul_f32 v48, v48, v56
    v_mul_f32 v49, v49, v57
    v_mul_f32 v50, v50, v58
    v_mul_f32 v51, v51, v59
    v_mul_f32 v52, v52, v60
    v_mul_f32 v53, v53, v61
    v_mul_f32 v54, v54, v62
    v_mul_f32 v55, v55, v63
    v_cvt_pk_bf16_f32 v64, v48, v49
    v_cvt_pk_bf16_f32 v65, v50, v51
    v_cvt_pk_bf16_f32 v66, v52, v53
    v_cvt_pk_bf16_f32 v67, v54, v55
    s_mov_b32 exec_lo, 0x30003
    s_mov_b32 exec_hi, 0x30003
    v_mov_b64 v[96:97], v[64:65]
    v_mov_b64 v[98:99], v[66:67]
    s_mov_b32 exec_lo, 0xc000c
    s_mov_b32 exec_hi, 0xc000c
    v_mov_b64 v[100:101], v[64:65]
    v_mov_b64 v[102:103], v[66:67]
    s_mov_b32 exec_lo, 0x300030
    s_mov_b32 exec_hi, 0x300030
    v_mov_b64 v[104:105], v[64:65]
    v_mov_b64 v[106:107], v[66:67]
    s_mov_b32 exec_lo, 0xc000c0
    s_mov_b32 exec_hi, 0xc000c0
    v_mov_b64 v[108:109], v[64:65]
    v_mov_b64 v[110:111], v[66:67]
    s_mov_b32 exec_lo, 0x3000300
    s_mov_b32 exec_hi, 0x3000300
    v_mov_b64 v[112:113], v[64:65]
    v_mov_b64 v[114:115], v[66:67]
    s_mov_b32 exec_lo, 0xc000c00
    s_mov_b32 exec_hi, 0xc000c00
    v_mov_b64 v[116:117], v[64:65]
    v_mov_b64 v[118:119], v[66:67]
    s_mov_b32 exec_lo, 0x30003000
    s_mov_b32 exec_hi, 0x30003000
    v_mov_b64 v[120:121], v[64:65]
    v_mov_b64 v[122:123], v[66:67]
    s_mov_b32 exec_lo, 0xc000c000
    s_mov_b32 exec_hi, 0xc000c000
    v_mov_b64 v[124:125], v[64:65]
    v_mov_b64 v[126:127], v[66:67]
    s_mov_b64 exec, -1
    v_mfma_f32_16x16x32_bf16 v[92:95], v[192:195], v[96:99], 0
    v_mfma_f32_16x16x32_bf16 v[92:95], v[196:199], v[100:103], v[92:95]
    v_mfma_f32_16x16x32_bf16 v[92:95], v[200:203], v[104:107], v[92:95]
    v_mfma_f32_16x16x32_bf16 v[92:95], v[204:207], v[108:111], v[92:95]
    v_mfma_f32_16x16x32_bf16 v[92:95], v[208:211], v[112:115], v[92:95]
    v_mfma_f32_16x16x32_bf16 v[92:95], v[212:215], v[116:119], v[92:95]
    v_mfma_f32_16x16x32_bf16 v[92:95], v[216:219], v[120:123], v[92:95]
    v_mfma_f32_16x16x32_bf16 v[92:95], v[220:223], v[124:127], v[92:95]
    s_nop 7
    v_cvt_pk_bf16_f32 v92, v92, v93
    v_cvt_pk_bf16_f32 v93, v94, v95
    v_min_u32 v92, -2, v92
    v_min_u32 v93, -2, v93
    buffer_store_dwordx2 v[92:93], v25, s[8:11], 0 offen sc1
    s_endpgm
L_f:
    s_cmp_eq_u32 s3, 0
    s_cbranch_scc0 L_fin
    s_lshr_b32 s52, s4, 2
    s_and_b32 s53, s4, 3
    s_lshl_b32 s56, s52, 10
    s_lshl_b32 s57, s53, 8
    s_add_u32 s56, s56, s57
    v_lshlrev_b32 v10, 11, v3
    v_lshl_add_u32 v10, v2, 4, v10
    v_add_u32 v10, s56, v10
    v_add_u32 v13, 393216, v10
    v_add_u32 v10, 344064, v10
    s_mov_b32 s58, 8192
    s_mov_b32 s59, 16384
    s_mov_b32 s60, 24576
    s_mov_b32 s61, 6144
    v_and_b32 v11, 1, v3
    v_lshlrev_b32 v11, 3, v11
    v_lshl_add_u32 v11, v2, 4, v11
    v_add_u32 v11, s56, v11
    v_add_u32 v12, 49152, v11
    global_load_dwordx2 v[44:45], v11, s[16:17]
    v_and_b32 v8, 1, v2
    v_lshlrev_b32 v8, 4, v8
    v_mov_b32 v9, 0xffff
    v_lshlrev_b32 v9, v8, v9
    v_bfe_u32 v8, v2, 1, 2
    v_cmp_eq_u32 vcc, 0, v8
    s_nop 1
    v_cndmask_b32 v40, 0, v9, vcc
    v_cmp_eq_u32 vcc, 1, v8
    s_nop 1
    v_cndmask_b32 v41, 0, v9, vcc
    v_cmp_eq_u32 vcc, 2, v8
    s_nop 1
    v_cndmask_b32 v42, 0, v9, vcc
    v_cmp_eq_u32 vcc, 3, v8
    s_nop 1
    v_cndmask_b32 v43, 0, v9, vcc
    s_mov_b32 s56, 0x3f803f80
    v_and_b32 v40, s56, v40
    v_and_b32 v41, s56, v41
    v_and_b32 v42, s56, v42
    v_and_b32 v43, s56, v43
    s_mov_b32 s12, s38
    s_mov_b32 s13, s39
    s_mov_b32 s14, 2048
    s_mov_b32 s15, 0x20000
    s_mov_b32 s47, 0
L_f_poll4:
    buffer_load_dwordx4 v[48:51], v10, s[8:11], 0 offen sc1
    buffer_load_dwordx4 v[52:55], v10, s[8:11], s58 offen sc1
    buffer_load_dwordx4 v[56:59], v10, s[8:11], s59 offen sc1
    buffer_load_dwordx4 v[60:63], v10, s[8:11], s60 offen sc1
    buffer_load_dwordx2 v[64:65], v12, s[8:11], 0 offen sc1
    buffer_load_dwordx2 v[66:67], v12, s[8:11], s61 offen sc1
    s_add_u32 s47, s47, 1
    s_waitcnt vmcnt(0)
    v_max3_u32 v18, v48, v49, v50
    v_max3_u32 v19, v51, v52, v53
    v_max3_u32 v18, v18, v54, v55
    v_max3_u32 v19, v19, v56, v57
    v_max3_u32 v18, v18, v58, v59
    v_max3_u32 v19, v19, v60, v61
    v_max3_u32 v18, v18, v62, v63
    v_max3_u32 v19, v19, v64, v65
    v_max3_u32 v18, v18, v66, v67
    v_max_u32 v18, v18, v19
    v_cmp_eq_u32 vcc, -1, v18
    s_cmp_ge_u32 s47, 20000
    s_cbranch_scc1 L_f_poll4_x
    s_cbranch_vccz L_f_poll4_x
    s_mov_b64 exec, vcc
    s_branch L_f_poll4
L_f_poll4_x:
    s_mov_b64 exec, -1
    v_mfma_f32_16x16x32_bf16 v[92:95], v[40:43], v[48:51], 0
    v_mfma_f32_16x16x32_bf16 v[92:95], v[40:43], v[52:55], v[92:95]
    v_mfma_f32_16x16x32_bf16 v[92:95], v[40:43], v[56:59], v[92:95]
    v_mfma_f32_16x16x32_bf16 v[92:95], v[40:43], v[60:63], v[92:95]
    v_lshlrev_b32 v100, 16, v44
    v_and_b32 v101, 0xffff0000, v44
    v_lshlrev_b32 v102, 16, v45
    v_and_b32 v103, 0xffff0000, v45
    v_lshlrev_b32 v104, 16, v64
    v_and_b32 v105, 0xffff0000, v64
    v_lshlrev_b32 v106, 16, v65
    v_and_b32 v107, 0xffff0000, v65
    v_lshlrev_b32 v108, 16, v66
    v_and_b32 v109, 0xffff0000, v66
    v_lshlrev_b32 v110, 16, v67
    v_and_b32 v111, 0xffff0000, v67
    v_fma_f32 v100, v92, v104, v100
    v_fma_f32 v101, v93, v105, v101
    v_fma_f32 v102, v94, v106, v102
    v_fma_f32 v103, v95, v107, v103
    s_mov_b32 s47, 0
L_f_poll5:
    s_mov_b32 s61, 0
    buffer_load_dwordx4 v[112:115], v13, s[8:11], s61 offen sc1
    s_add_u32 s61, s61, 8192
    buffer_load_dwordx4 v[116:119], v13, s[8:11], s61 offen sc1
    s_add_u32 s61, s61, 8192
    buffer_load_dwordx4 v[120:123], v13, s[8:11], s61 offen sc1
    s_add_u32 s61, s61, 8192
    buffer_load_dwordx4 v[124:127], v13, s[8:11], s61 offen sc1
    s_add_u32 s61, s61, 8192
    buffer_load_dwordx4 v[128:131], v13, s[8:11], s61 offen sc1
    s_add_u32 s61, s61, 8192
    buffer_load_dwordx4 v[132:135], v13, s[8:11], s61 offen sc1
    s_add_u32 s61, s61, 8192
    buffer_load_dwordx4 v[136:139], v13, s[8:11], s61 offen sc1
    s_add_u32 s61, s61, 8192
    buffer_load_dwordx4 v[140:143], v13, s[8:11], s61 offen sc1
    s_add_u32 s61, s61, 8192
    buffer_load_dwordx4 v[144:147], v13, s[8:11], s61 offen sc1
    s_add_u32 s61, s61, 8192
    buffer_load_dwordx4 v[148:151], v13, s[8:11], s61 offen sc1
    s_add_u32 s61, s61, 8192
    buffer_load_dwordx4 v[152:155], v13, s[8:11], s61 offen sc1
    s_add_u32 s61, s61, 8192
    buffer_load_dwordx4 v[156:159], v13, s[8:11], s61 offen sc1
    s_add_u32 s61, s61, 8192
    buffer_load_dwordx4 v[160:163], v13, s[8:11], s61 offen sc1
    s_add_u32 s61, s61, 8192
    buffer_load_dwordx4 v[164:167], v13, s[8:11], s61 offen sc1
    s_add_u32 s47, s47, 1
    s_waitcnt vmcnt(0)
    v_max3_u32 v18, v112, v113, v114
    v_max3_u32 v19, v115, v116, v117
    v_max3_u32 v18, v18, v118, v119
    v_max3_u32 v19, v19, v120, v121
    v_max3_u32 v18, v18, v122, v123
    v_max3_u32 v19, v19, v124, v125
    v_max3_u32 v18, v18, v126, v127
    v_max3_u32 v19, v19, v128, v129
    v_max3_u32 v18, v18, v130, v131
    v_max3_u32 v19, v19, v132, v133
    v_max3_u32 v18, v18, v134, v135
    v_max3_u32 v19, v19, v136, v137
    v_max3_u32 v18, v18, v138, v139
    v_max3_u32 v19, v19, v140, v141
    v_max3_u32 v18, v18, v142, v143
    v_max3_u32 v19, v19, v144, v145
    v_max3_u32 v18, v18, v146, v147
    v_max3_u32 v19, v19, v148, v149
    v_max3_u32 v18, v18, v150, v151
    v_max3_u32 v19, v19, v152, v153
    v_max3_u32 v18, v18, v154, v155
    v_max3_u32 v19, v19, v156, v157
    v_max3_u32 v18, v18, v158, v159
    v_max3_u32 v19, v19, v160, v161
    v_max3_u32 v18, v18, v162, v163
    v_max3_u32 v19, v19, v164, v165
    v_max3_u32 v18, v18, v166, v167
    v_max_u32 v18, v18, v19
    v_cmp_eq_u32 vcc, -1, v18
    s_cmp_ge_u32 s47, 20000
    s_cbranch_scc1 L_f_poll5_x
    s_cbranch_vccz L_f_poll5_x
    s_mov_b64 exec, vcc
    s_branch L_f_poll5
L_f_poll5_x:
    s_mov_b64 exec, -1
    v_mfma_f32_16x16x32_bf16 v[92:95], v[40:43], v[112:115], 0
    v_mfma_f32_16x16x32_bf16 v[96:99], v[40:43], v[116:119], 0
    v_mfma_f32_16x16x32_bf16 v[92:95], v[40:43], v[120:123], v[92:95]
    v_mfma_f32_16x16x32_bf16 v[96:99], v[40:43], v[124:127], v[96:99]
    v_mfma_f32_16x16x32_bf16 v[92:95], v[40:43], v[128:131], v[92:95]
    v_mfma_f32_16x16x32_bf16 v[96:99], v[40:43], v[132:135], v[96:99]
    v_mfma_f32_16x16x32_bf16 v[92:95], v[40:43], v[136:139], v[92:95]
    v_mfma_f32_16x16x32_bf16 v[96:99], v[40:43], v[140:143], v[96:99]
    v_mfma_f32_16x16x32_bf16 v[92:95], v[40:43], v[144:147], v[92:95]
    v_mfma_f32_16x16x32_bf16 v[96:99], v[40:43], v[148:151], v[96:99]
    v_mfma_f32_16x16x32_bf16 v[92:95], v[40:43], v[152:155], v[92:95]
    v_mfma_f32_16x16x32_bf16 v[96:99], v[40:43], v[156:159], v[96:99]
    v_mfma_f32_16x16x32_bf16 v[92:95], v[40:43], v[160:163], v[92:95]
    v_mfma_f32_16x16x32_bf16 v[96:99], v[40:43], v[164:167], v[96:99]
    s_nop 7
    v_add_f32 v92, v92, v96
    v_add_f32 v93, v93, v97
    v_add_f32 v94, v94, v98
    v_add_f32 v95, v95, v99
    v_fma_f32 v92, v92, v108, v100
    v_fma_f32 v93, v93, v109, v101
    v_fma_f32 v94, v94, v110, v102
    v_fma_f32 v95, v95, v111, v103
    v_cvt_pk_bf16_f32 v92, v92, v93
    v_cvt_pk_bf16_f32 v93, v94, v95
    s_mov_b32 exec_hi, 0
    buffer_store_dwordx2 v[92:93], v11, s[12:15], 0 offen
    s_mov_b64 exec, -1
    s_cmp_eq_u32 s4, 0
    s_cbranch_scc0 L_f_done
    v_mov_b32 v8, 0
    v_mov_b32 v9, s44
    s_mov_b64 exec, 1
    buffer_store_dword v9, v8, s[8:11], 0 offen sc1
    s_mov_b64 exec, -1
L_f_done:
    s_endpgm
L_dump:
L_end:
    s_endpgm

.section .rodata,"a"
.p2align 6
.amdhsa_kernel adaLN_cond__sliding_block_cached__glu_gated_bilinear__decode_kernel
  .amdhsa_next_free_vgpr 240
  .amdhsa_next_free_sgpr 102
  .amdhsa_accum_offset 240
  .amdhsa_group_segment_fixed_size 0
  .amdhsa_kernarg_size 112
  .amdhsa_user_sgpr_count 2
  .amdhsa_user_sgpr_kernarg_segment_ptr 1
  .amdhsa_system_sgpr_workgroup_id_x 1
.end_amdhsa_kernel
```
